```python
import torch

def _softmax(x, axis=-1):
    return torch.softmax(x, dim=axis)
def _gelu(x):
    return torch.nn.functional.gelu(x, approximate="tanh")
def _silu(x):
    return torch.nn.functional.silu(x)
def _sigmoid(x):
    return torch.sigmoid(x)
def _layernorm(x, axis=-1, eps=1e-5):
    m = x.mean(dim=axis, keepdim=True)
    v = x.var(dim=axis, keepdim=True, unbiased=False)
    return (x - m) / torch.sqrt(v + eps)
def _scatter_add(tgt, idx, src, axis=0):
    return tgt.clone().index_add_(axis, idx, src)
def _segment_sum(src, seg, n):
    out = torch.zeros((n,) + src.shape[1:], dtype=src.dtype)
    return out.index_add_(0, seg, src)
def _pad(x, pw):
    flat = tuple(v for pair in reversed(pw) for v in pair)
    return torch.nn.functional.pad(x, flat)

kernel_name = 'sequential_preLN__ssm_conv_s4__moe_arch_mod__prompt'

def setup_inputs():

    _w = (lambda a: (lambda t: t.to(torch.bfloat16) if t.is_floating_point() else t)(torch.as_tensor(a)))
    def _A_setup():
        B, L, D, N = 1, 2048, 448, 256
        A_re = -(lambda _x: torch.exp(torch.as_tensor(_x)))((lambda *s: torch.randn(*s, dtype=torch.bfloat16) * 6.4)(D, N))
        A_im = torch.pi * (lambda *s: torch.randn(*s, dtype=torch.bfloat16) * 0.05)(D, N)
        B_re = (lambda *s: torch.randn(*s, dtype=torch.bfloat16) * 0.05)(D, N)
        B_im = (lambda *s: torch.randn(*s, dtype=torch.bfloat16) * 0.05)(D, N)
        C_re = (lambda *s: torch.randn(*s, dtype=torch.bfloat16) * 0.05)(D, N)
        C_im = (lambda *s: torch.randn(*s, dtype=torch.bfloat16) * 0.05)(D, N)
        log_dt = (lambda *s: torch.randn(*s, dtype=torch.bfloat16) * 0.05)(D) * 0.5 - 4.0
        Dskip = (lambda *s: torch.randn(*s, dtype=torch.bfloat16) * 0.05)(D)
        return {
            "u": _w((lambda *s: torch.randn(*s, dtype=torch.bfloat16) * 0.05)(B, L, D)),
            "A_re": _w(A_re),
            "A_im": _w(A_im),
            "B_re": _w(B_re),
            "B_im": _w(B_im),
            "C_re": _w(C_re),
            "C_im": _w(C_im),
            "log_dt": _w(log_dt),
            "Dskip": _w(Dskip),
        }
    _A_in = _A_setup()

    def _B_setup():
        B, S, D, F, C = 1, 2048, 448, 1792, 1
        return {
            "x": _w((lambda *s: torch.randn(*s, dtype=torch.bfloat16) * 0.05)(B, S, D)),
            "w_r": _w((lambda *s: torch.randn(*s, dtype=torch.bfloat16) * 0.05)(D)),
            "w_gate": _w((lambda *s: torch.randn(*s, dtype=torch.bfloat16) * 0.05)(D, F)),
            "w_up": _w((lambda *s: torch.randn(*s, dtype=torch.bfloat16) * 0.05)(D, F)),
            "w_down": _w((lambda *s: torch.randn(*s, dtype=torch.bfloat16) * 0.05)(F, D)),
        }
    _B_in = _B_setup()

    return {
        "A_u": _A_in["u"],
        "A_A_re": _A_in["A_re"],
        "A_A_im": _A_in["A_im"],
        "A_B_re": _A_in["B_re"],
        "A_B_im": _A_in["B_im"],
        "A_C_re": _A_in["C_re"],
        "A_C_im": _A_in["C_im"],
        "A_log_dt": _A_in["log_dt"],
        "A_Dskip": _A_in["Dskip"],
        "B_x": _B_in["x"],
        "B_w_r": _B_in["w_r"],
        "B_w_gate": _B_in["w_gate"],
        "B_w_up": _B_in["w_up"],
        "B_w_down": _B_in["w_down"],
    }

def reference(A_u, A_A_re, A_A_im, A_B_re, A_B_im, A_C_re, A_C_im, A_log_dt, A_Dskip, B_x, B_w_r, B_w_gate, B_w_up, B_w_down):
    def _A_ref(u, A_re, A_im, B_re, B_im, C_re, C_im, log_dt, Dskip):
        Bsz, L, D = u.shape
        dt = torch.exp(log_dt)[:, None]
        A = A_re + 1j * A_im
        Bc = B_re + 1j * B_im
        Cc = C_re + 1j * C_im
        logdA = dt * A
        dB = dt * Bc
        l = (lambda x, dt: x.to(dt))(torch.arange(L), A_re.dtype)
        P = torch.exp(logdA[:, :, None] * l[None, None, :])
        K = torch.einsum("dn,dnl,dn->dl", Cc, P, dB).real
        L2 = 2 * L
        Kp = _pad(K, ((0, 0), (0, L)))
        up = (lambda x, *d: x.permute(*d))(u, 0, 2, 1)
        up = _pad(up, ((0, 0), (0, 0), (0, L)))
        Kf = (lambda x, axes=(-2,-1): torch.fft.rfft2(x.float(), dim=axes))(Kp[:, None, :], axes=(-2, -1))
        Uf = (lambda x, axes=(-2,-1): torch.fft.rfft2(x.float(), dim=axes))(up[:, :, None, :], axes=(-2, -1))
        Yf = Uf * Kf[None, :, :, :]
        y = (lambda x, s, axes=(-2,-1): torch.fft.irfft2(x, s=s, dim=axes).to(torch.bfloat16))(Yf, (1, L2), axes=(-2, -1))[:, :, 0, :L]
        y = (lambda x, *d: x.permute(*d))(y, 0, 2, 1) + u * Dskip[None, None, :]
        return y

    def _B_ref(x, w_r, w_gate, w_up, w_down):
        B, S, D = x.shape
        C = 1
        r = x @ w_r
        idx = torch.argsort(-r, axis=-1)[:, :C]
        idx_e = (lambda x, n, axis: torch.repeat_interleave(x, n, dim=axis))(idx.reshape(B, C, 1), D, axis=2)
        x_sel = (lambda x, i, axis: torch.take_along_dim(x, i, dim=axis))(x, idx_e, axis=1)
        g = _silu(x_sel @ w_gate)
        u = x_sel @ w_up
        y = (g * u) @ w_down
        r_sel = _sigmoid((lambda x, i, axis: torch.take_along_dim(x, i, dim=axis))(r, idx, axis=1))
        y = y * r_sel.reshape(B, C, 1)
        b_off = (torch.arange(B) * S).reshape(B, 1)
        flat_idx = (idx + b_off).reshape(B * C)
        zero = (x * 0.0).reshape(B * S, D)
        upd = _scatter_add(zero, flat_idx, y.reshape(B * C, D), axis=0)
        return x + upd.reshape(B, S, D)

    x = A_u
    h = x + _A_ref(_layernorm(x, axis=-1), A_A_re, A_A_im, A_B_re, A_B_im, A_C_re, A_C_im, A_log_dt, A_Dskip)
    h2 = h + _B_ref(_layernorm(h, axis=-1), B_w_r, B_w_gate, B_w_up, B_w_down)
    return h2
```

```asm
; @launch grid=(256,1,1) block=(512,1,1) lds=144016
.amdgcn_target "amdgcn-amd-amdhsa--gfx950"
.text
.globl sequential_preLN__ssm_conv_s4__moe_arch_mod__prompt_kernel
.p2align 12
.p2align 8
.type sequential_preLN__ssm_conv_s4__moe_arch_mod__prompt_kernel,@function
sequential_preLN__ssm_conv_s4__moe_arch_mod__prompt_kernel:
    s_cmp_ge_u32 s2, 256
    s_cbranch_scc1 L_exit0
    s_load_dwordx16 s[4:19], s[0:1], 0
    s_load_dwordx16 s[20:35], s[0:1], 64
    s_load_dwordx2 s[36:37], s[0:1], 128
    v_lshrrev_b32 v4, 6, v0
    s_getpc_b64 s[62:63]
L_pc:
    v_readfirstlane_b32 s40, v4
    v_lshlrev_b32 v5, 7, v0
    v_min_u32 v5, L_tend-L_pc-4, v5
    s_cmp_ge_u32 s40, 3
    s_cbranch_scc1 L_nopf
    global_load_dword v36, v5, s[62:63]
L_nopf:
    v_and_b32 v1, 63, v0
    s_and_b32 s44, s2, 7
    s_lshr_b32 s41, s2, 3
    s_lshl_b32 s38, s44, 5
    s_add_u32 s38, s38, s41
    s_lshl3_add_u32 s60, s38, s40
    s_mul_i32 s53, s60, 896
    v_lshlrev_b32 v2, 4, v1
    v_add_u32 v3, s53, v2
    s_min_u32 s53, s41, 27
    s_mul_i32 s39, s44, 28
    s_add_u32 s39, s39, s53
    s_and_b32 s54, s40, 3
    s_lshr_b32 s100, s40, 2
    s_lshl1_add_u32 s100, s54, s100
    s_lshl3_add_u32 s53, s39, s100
    s_lshl_b32 s53, s53, 7
    v_lshl_add_u32 v4, v1, 1, s53
    s_lshl_b32 s100, s100, 8
    s_lshl_b32 s55, s39, 2
    s_add_u32 s62, s62, L_table-L_pc
    s_addc_u32 s63, s63, 0
    v_and_b32 v58, 15, v0
    v_bfe_u32 v59, v0, 4, 2
    v_lshlrev_b32 v6, 4, v0
    v_mov_b32 v12, 0
    v_mov_b32 v13, 0
    v_mov_b32 v14, 0
    v_mov_b32 v15, 0
    v_mov_b32 v16, 0
    v_mov_b32 v17, 0
    v_mov_b32 v18, 0
    v_mov_b32 v19, 0
    v_mov_b32 v20, 0
    v_mov_b32 v21, 0
    v_mov_b32 v22, 0
    v_mov_b32 v23, 0
    v_mov_b32 v32, v2
    v_mov_b32 v35, v2
    v_mov_b32 v46, v2
    v_mov_b32 v49, v2
    v_mov_b32 v50, v2
    v_mov_b32 v51, v2
    v_mov_b32 v56, v2
    v_mov_b32 v57, v2
    v_mov_b32 v62, v2
    v_mov_b32 v65, v2
    v_mov_b32 v83, v2
    s_cmp_ge_u32 s41, 28
    s_mov_b32 exec_hi, 0x00ffffff
    s_waitcnt lgkmcnt(0)
    global_load_dwordx4 v[12:15], v3, s[4:5]
    s_load_dword s42, s[36:37], 0
    s_load_dword s43, s[18:19], s55
    s_mov_b64 exec, -1
    s_barrier
    s_cbranch_scc1 L_ncinit
    global_load_short_d16_hi v44, v4, s[6:7]
    global_load_short_d16_hi v45, v4, s[8:9]
    global_load_short_d16_hi v46, v4, s[10:11]
    global_load_short_d16_hi v47, v4, s[12:13]
    global_load_short_d16_hi v48, v4, s[14:15]
    global_load_short_d16_hi v49, v4, s[16:17]
    v_mov_b32 v24, 0
    v_mov_b32 v25, 0
    v_mov_b32 v26, 0
    v_mov_b32 v27, 0
    v_add_u32 v7, 109392, v6
    ds_write_b128 v7, v[24:27]
    ds_write_b128 v7, v[24:27] offset:8192
    ds_write_b128 v7, v[24:27] offset:16384
    s_lshr_b32 s53, s40, 1
    s_lshl_b32 s53, s53, 10
    v_add_u32 v32, s53, v2
    s_cmp_ge_u32 s40, 4
    s_cbranch_scc1 L_init47
    v_add_u32 v83, 4096, v2
    s_and_b32 s55, s40, 1
    s_mul_i32 s53, s55, 4672
    s_add_u32 s53, s53, 126288
    v_lshl_add_u32 v4, v59, 4, s53
    v_lshl_add_u32 v61, v58, 5, v4
    v_lshl_add_u32 v64, v58, 4, v4
    s_mul_i32 s53, s55, 8448
    s_add_u32 s53, s53, 109392
    v_lshl_add_u32 v4, v59, 4, s53
    v_xor_b32 v5, 15, v58
    v_lshl_add_u32 v62, v5, 3, v4
    v_and_b32 v7, 1, v5
    v_mul_u32_u24 v7, 4220, v7
    v_lshl_add_u32 v7, v5, 2, v7
    v_add_u32 v63, v7, v4
    v_and_b32 v7, 3, v5
    v_mul_u32_u24 v7, 2110, v7
    v_lshl_add_u32 v7, v5, 1, v7
    v_add_u32 v60, v7, v4
    s_mul_i32 s53, s39, 8320
    s_lshl_b32 s54, s55, 6
    s_add_u32 s53, s53, s54
    s_add_u32 s53, s53, 2100224
    v_lshrrev_b32 v5, 2, v58
    v_mul_u32_u24 v5, 192, v5
    v_lshl_add_u32 v4, v58, 4, s53
    v_add_u32 v4, v4, v5
    v_and_b32 v5, 1, v59
    v_lshl_add_u32 v4, v5, 10, v4
    v_lshrrev_b32 v5, 1, v59
    v_lshl_add_u32 v65, v5, 7, v4
    s_lshl_b32 s53, s40, 9
    v_lshl_add_u32 v5, v5, 4, s53
    v_and_b32 v4, 31, v0
    s_movk_i32 s54, 2064
    v_mad_u32_u24 v67, v4, s54, v5
    v_and_b32 v66, 0xf0, v67
    v_add_u32 v66, 109568, v66
    s_mov_b32 exec_lo, 0x001fffff
    s_mov_b32 exec_hi, 0x001fffff
    v_mov_b32 v66, v67
    s_mov_b64 exec, -1
    s_branch L_common
L_init47:
    s_lshl_b32 s53, s38, 12
    s_add_u32 s53, s53, 4194304
    v_add_u32 v57, s53, v2
    s_and_b32 s53, s40, 1
    s_lshl1_add_u32 s53, s41, s53
    s_mul_i32 s53, s53, 28672
    s_min_u32 s54, s44, 6
    s_lshl_b32 s54, s54, 9
    s_add_u32 s53, s53, s54
    s_bitcmp1_b32 s40, 1
    s_cselect_b32 s22, s28, s26
    s_cselect_b32 s23, s29, s27
    v_lshrrev_b32 v4, 3, v1
    v_mul_u32_u24 v4, 3072, v4
    v_lshl_add_u32 v4, v1, 6, v4
    v_add_u32 v56, s53, v4
    s_mul_i32 s53, s39, 8320
    s_add_u32 s53, s53, 2101248
    v_add_u32 v62, s53, v2
    s_lshr_b32 s53, s39, 1
    s_lshl_b32 s53, s53, 7
    s_and_b32 s54, s39, 1
    s_lshl_b32 s54, s54, 5
    s_add_u32 s53, s53, s54
    s_add_u32 s53, s53, 4096
    v_lshrrev_b32 v4, 2, v0
    v_mul_u32_u24 v4, 14464, v4
    v_bfe_u32 v5, v0, 1, 1
    v_lshl_add_u32 v4, v5, 6, v4
    v_and_b32 v5, 1, v0
    v_lshl_add_u32 v4, v5, 4, v4
    v_add_u32 v51, s53, v4
    v_subrev_u32 v50, 925696, v51
    v_mul_u32_u24 v4, 4664, v5
    v_lshl_add_u32 v4, v0, 3, v4
    v_add_u32 v55, 124720, v4
    s_branch L_common
L_ncinit:
    s_lshl2_add_u32 s61, s44, s41
    s_sub_u32 s61, s61, 28
    s_cmp_lg_u32 s40, 7
    s_cbranch_scc1 L_nci0
    s_lshl_b32 s53, s38, 12
    s_add_u32 s53, s53, 4194304
    v_add_u32 v4, s53, v2
    v_mov_b32 v68, -1
    v_mov_b32 v69, -1
    v_mov_b32 v70, -1
    v_mov_b32 v71, -1
    global_store_dwordx4 v4, v[68:71], s[36:37] sc1
    global_store_dwordx4 v4, v[68:71], s[36:37] offset:1024 sc1
    global_store_dwordx4 v4, v[68:71], s[36:37] offset:2048 sc1
    global_store_dwordx4 v4, v[68:71], s[36:37] offset:3072 sc1
L_nci0:
    s_cmp_lg_u32 s44, 7
    s_cbranch_scc1 L_nci1
    s_waitcnt vmcnt(0)
    s_branch L_common
L_nci1:
    s_lshl3_add_u32 s53, s61, s40
    s_mul_i32 s53, s53, 7168
    v_add_u32 v56, s53, v2
    s_mul_i32 s97, s40, 7424
    s_add_u32 s97, s97, 57344
    s_mov_b32 exec_hi, 0x00ffffff
    s_mov_b32 s101, 4
L_dma0:
    s_mov_b32 m0, s97
    s_add_u32 s97, s97, 928
    global_load_lds_dwordx4 v56, s[30:31]
    v_add_u32 v56, 896, v56
    s_sub_u32 s101, s101, 1
    s_cmp_lg_u32 s101, 0
    s_cbranch_scc1 L_dma0
L_common:
    s_mov_b32 exec_hi, 0x00ffffff
    global_load_dwordx4 v[20:23], v2, s[24:25]
    global_load_dwordx4 v[16:19], v2, s[20:21]
    s_mov_b64 exec, -1
    s_mov_b32 s46, 0x3f803f80
    s_mov_b32 s49, 0x60006000
    s_mov_b32 s58, 0
    s_lshl_b32 s45, s40, 8
    s_mul_i32 s53, s40, 960
    s_add_u32 s53, s53, 135632
    v_add_u32 v52, s53, v2
    v_bfe_u32 v4, v0, 2, 2
    v_and_b32 v7, 3, v0
    v_mul_u32_u24 v4, 960, v4
    v_lshrrev_b32 v5, 4, v0
    v_lshl_add_u32 v4, v5, 5, v4
    v_lshl_add_u32 v4, v7, 3, v4
    v_add_u32 v53, 135632, v4
    s_lshr_b32 s53, s38, 1
    s_mul_i32 s53, s53, 14464
    s_and_b32 s54, s38, 1
    s_lshl_b32 s54, s54, 6
    s_add_u32 s53, s53, s54
    s_add_u32 s53, s53, 4096
    v_and_b32 v4, 0x1fc0, v6
    v_add3_u32 v54, v4, v6, s53
    v_and_b32 v5, 1, v0
    v_lshlrev_b32 v28, 3, v5
    v_add_u32 v29, 2, v28
    v_add_u32 v30, 4, v28
    v_add_u32 v31, 6, v28
    s_mov_b64 exec, 0
    s_cmp_eq_u32 s40, 0
    s_cbranch_scc1 L_padB_p1
    s_cmp_eq_u32 s40, 1
    s_cbranch_scc1 L_padB_0
    s_cmp_eq_u32 s40, 2
    s_cbranch_scc1 L_padB_p2
    s_cmp_eq_u32 s40, 3
    s_cbranch_scc1 L_padB_1
L_padretB:
    s_mov_b64 exec, -1
    s_cmp_lt_u32 s41, 28
    s_cbranch_scc1 L_xw
    s_waitcnt vmcnt(6)
L_xw:
    s_waitcnt vmcnt(8) lgkmcnt(0)
    v_dot2_f32_bf16 v92, v12, s46, 0
    v_dot2_f32_bf16 v93, v12, v12, 0
    v_dot2_f32_bf16 v92, v13, s46, v92
    v_dot2_f32_bf16 v93, v13, v13, v93
    v_dot2_f32_bf16 v92, v14, s46, v92
    v_dot2_f32_bf16 v93, v14, v14, v93
    v_dot2_f32_bf16 v92, v15, s46, v92
    v_dot2_f32_bf16 v93, v15, v15, v93
    s_add_u32 s42, s42, 0x9e3779b1
    v_lshlrev_b32 v84, 16, v12
    v_and_b32 v85, 0xffff0000, v12
    v_add_f32_dpp v92, v92, v92 quad_perm:[1,0,3,2] row_mask:0xf bank_mask:0xf
    v_add_f32_dpp v93, v93, v93 quad_perm:[1,0,3,2] row_mask:0xf bank_mask:0xf
    v_lshlrev_b32 v86, 16, v13
    v_add_f32_dpp v92, v92, v92 quad_perm:[2,3,0,1] row_mask:0xf bank_mask:0xf
    v_add_f32_dpp v93, v93, v93 quad_perm:[2,3,0,1] row_mask:0xf bank_mask:0xf
    v_and_b32 v87, 0xffff0000, v13
    v_add_f32_dpp v92, v92, v92 row_half_mirror row_mask:0xf bank_mask:0xf
    v_add_f32_dpp v93, v93, v93 row_half_mirror row_mask:0xf bank_mask:0xf
    v_lshlrev_b32 v88, 16, v14
    v_add_f32_dpp v92, v92, v92 row_mirror row_mask:0xf bank_mask:0xf
    v_add_f32_dpp v93, v93, v93 row_mirror row_mask:0xf bank_mask:0xf
    v_and_b32 v89, 0xffff0000, v14
    v_add_f32_dpp v92, v92, v92 row_bcast:15 row_mask:0xa bank_mask:0xf
    v_add_f32_dpp v93, v93, v93 row_bcast:15 row_mask:0xa bank_mask:0xf
    v_lshlrev_b32 v90, 16, v15
    v_add_f32_dpp v92, v92, v92 row_bcast:31 row_mask:0xc bank_mask:0xf
    v_add_f32_dpp v93, v93, v93 row_bcast:31 row_mask:0xc bank_mask:0xf
    v_and_b32 v91, 0xffff0000, v15
    v_mul_f32 v92, 0xbb124925, v92
    v_mul_f32 v93, 0x3b124925, v93
    v_fma_f32 v93, -v92, v92, v93
    v_max_f32 v93, 0, v93
    v_cvt_pk_bf16_f32 v93, 0, v93
    v_add_f32 v93, 0x3727c5ac, v93
    v_cvt_pk_bf16_f32 v93, 0, v93
    v_sqrt_f32 v93, v93
    v_cvt_pk_bf16_f32 v92, 0, v92
    v_cvt_pk_bf16_f32 v93, 0, v93
    v_rcp_f32 v93, v93
    v_alignbit_b32 v28, s42, s42, v28
    v_mul_f32 v93, 0x1b800000, v93
    v_mul_f32 v92, v92, v93
    v_readlane_b32 s51, v93, 63
    v_readlane_b32 s50, v92, 63
    v_alignbit_b32 v29, s42, s42, v29
    v_alignbit_b32 v30, s42, s42, v30
    v_pk_fma_f32 v[84:85], v[84:85], s[50:51], s[50:51] op_sel:[0,1,0] op_sel_hi:[1,1,0]
    v_pk_fma_f32 v[86:87], v[86:87], s[50:51], s[50:51] op_sel:[0,1,0] op_sel_hi:[1,1,0]
    v_pk_fma_f32 v[88:89], v[88:89], s[50:51], s[50:51] op_sel:[0,1,0] op_sel_hi:[1,1,0]
    v_pk_fma_f32 v[90:91], v[90:91], s[50:51], s[50:51] op_sel:[0,1,0] op_sel_hi:[1,1,0]
    v_cvt_pk_bf16_f32 v24, v84, v85
    v_cvt_pk_bf16_f32 v25, v86, v87
    v_cvt_pk_bf16_f32 v26, v88, v89
    v_cvt_pk_bf16_f32 v27, v90, v91
    s_mov_b32 exec_hi, 0x00ffffff
    ds_write_b128 v52, v[24:27]
    s_mov_b64 exec, -1
    v_alignbit_b32 v31, s42, s42, v31
    s_cmp_ge_u32 s41, 28
    s_cbranch_scc1 L_b1
    s_lshl_b32 s53, s43, 16
    s_and_b32 s54, s43, 0xffff0000
    s_bitcmp1_b32 s40, 1
    s_cselect_b32 s53, s54, s53
    v_mov_b32 v4, 0x3fb8aa3b
    v_mul_f32 v4, s53, v4
    v_exp_f32 v4, v4
    s_mov_b32 m0, s100
    v_cvt_pk_bf16_f32 v4, 0, v4
    v_mul_f32 v6, 0x3fb8aa3b, v4
    v_mul_f32 v7, 0.15915494, v4
    v_mul_f32 v4, 0x63800000, v4
    s_waitcnt vmcnt(2)
    v_pk_mul_f32 v[44:45], v[44:45], v[6:7]
    v_pk_mul_f32 v[46:47], v[46:47], v[4:5] op_sel:[0,0] op_sel_hi:[1,0]
    v_pk_mul_f32 v[118:119], v[48:49], v[46:47] op_sel:[0,0] op_sel_hi:[1,0] neg_hi:[1,0]
    v_pk_fma_f32 v[102:103], v[48:49], v[46:47], v[118:119] op_sel:[1,1,0] op_sel_hi:[0,1,1] neg_lo:[1,0,0] neg_hi:[1,0,0]
    s_mov_b32 s56, 0x41000000
    s_mov_b32 s57, 0x43800000
    v_pk_mul_f32 v[46:47], v[44:45], s[56:57] op_sel:[0,0] op_sel_hi:[1,0]
    v_pk_mul_f32 v[48:49], v[44:45], s[56:57] op_sel:[0,1] op_sel_hi:[1,1]
    v_fract_f32 v45, v45
    v_fract_f32 v47, v47
    v_fract_f32 v49, v49
    v_exp_f32 v44, v44
    v_exp_f32 v46, v46
    v_exp_f32 v48, v48
    v_cos_f32 v96, v45
    v_sin_f32 v97, v45
    v_cos_f32 v98, v47
    v_sin_f32 v99, v47
    v_cos_f32 v100, v49
    v_sin_f32 v101, v49
    v_pk_mul_f32 v[96:97], v[96:97], v[44:45] op_sel:[0,0] op_sel_hi:[1,0]
    v_pk_mul_f32 v[98:99], v[98:99], v[46:47] op_sel:[0,0] op_sel_hi:[1,0]
    v_pk_mul_f32 v[100:101], v[100:101], v[48:49] op_sel:[0,0] op_sel_hi:[1,0]
L_b1:
    s_cmp_eq_u32 s40, 7
    s_waitcnt lgkmcnt(0)
    s_barrier
    s_cbranch_scc1 L_nopub
    ds_read_b64_tr_b16 v[8:9], v53
    ds_read_b64_tr_b16 v[10:11], v53 offset:3840
    s_waitcnt lgkmcnt(1)
    v_bfi_b32 v8, s49, v28, v8
    v_bfi_b32 v9, s49, v29, v9
    s_waitcnt lgkmcnt(0)
    v_bfi_b32 v10, s49, v30, v10
    v_bfi_b32 v11, s49, v31, v11
    global_store_dwordx4 v54, v[8:11], s[36:37] sc1
L_nopub:
    s_cmp_ge_u32 s41, 28
    s_cbranch_scc1 L_nonconv
    global_load_dwordx4 v[32:35], v32, s[62:63]
    s_add_u32 s54, s100, 43344
    s_mov_b32 s101, 0
    s_cmp_lt_u32 s40, 4
    v_cvt_pk_bf16_f32 v120, v102, v103
    ds_write_addtid_b32 v120 offset:0
    v_pk_mul_f32 v[118:119], v[102:103], v[96:97] op_sel:[0,0] op_sel_hi:[1,0]
    v_pk_fma_f32 v[104:105], v[102:103], v[96:97], v[118:119] op_sel:[1,1,0] op_sel_hi:[0,1,1] neg_hi:[1,0,0]
    v_cvt_pk_bf16_f32 v121, v104, v105
    ds_write_addtid_b32 v121 offset:8256
    v_pk_mul_f32 v[118:119], v[104:105], v[96:97] op_sel:[0,0] op_sel_hi:[1,0]
    v_pk_fma_f32 v[106:107], v[104:105], v[96:97], v[118:119] op_sel:[1,1,0] op_sel_hi:[0,1,1] neg_hi:[1,0,0]
    v_cvt_pk_bf16_f32 v122, v106, v107
    ds_write_addtid_b32 v122 offset:2064
    v_pk_mul_f32 v[118:119], v[106:107], v[96:97] op_sel:[0,0] op_sel_hi:[1,0]
    v_pk_fma_f32 v[108:109], v[106:107], v[96:97], v[118:119] op_sel:[1,1,0] op_sel_hi:[0,1,1] neg_hi:[1,0,0]
    v_cvt_pk_bf16_f32 v123, v108, v109
    ds_write_addtid_b32 v123 offset:10320
    v_pk_mul_f32 v[118:119], v[108:109], v[96:97] op_sel:[0,0] op_sel_hi:[1,0]
    v_pk_fma_f32 v[110:111], v[108:109], v[96:97], v[118:119] op_sel:[1,1,0] op_sel_hi:[0,1,1] neg_hi:[1,0,0]
    v_cvt_pk_bf16_f32 v120, v110, v111
    ds_write_addtid_b32 v120 offset:4128
    v_pk_mul_f32 v[118:119], v[110:111], v[96:97] op_sel:[0,0] op_sel_hi:[1,0]
    v_pk_fma_f32 v[112:113], v[110:111], v[96:97], v[118:119] op_sel:[1,1,0] op_sel_hi:[0,1,1] neg_hi:[1,0,0]
    v_cvt_pk_bf16_f32 v121, v112, v113
    ds_write_addtid_b32 v121 offset:12384
    v_pk_mul_f32 v[118:119], v[112:113], v[96:97] op_sel:[0,0] op_sel_hi:[1,0]
    v_pk_fma_f32 v[114:115], v[112:113], v[96:97], v[118:119] op_sel:[1,1,0] op_sel_hi:[0,1,1] neg_hi:[1,0,0]
    v_cvt_pk_bf16_f32 v122, v114, v115
    ds_write_addtid_b32 v122 offset:6192
    v_pk_mul_f32 v[118:119], v[114:115], v[96:97] op_sel:[0,0] op_sel_hi:[1,0]
    v_pk_fma_f32 v[116:117], v[114:115], v[96:97], v[118:119] op_sel:[1,1,0] op_sel_hi:[0,1,1] neg_hi:[1,0,0]
    v_cvt_pk_bf16_f32 v123, v116, v117
    ds_write_addtid_b32 v123 offset:14448
    v_pk_mul_f32 v[118:119], v[102:103], v[100:101] op_sel:[0,0] op_sel_hi:[1,0]
    v_pk_fma_f32 v[102:103], v[102:103], v[100:101], v[118:119] op_sel:[1,1,0] op_sel_hi:[0,1,1] neg_hi:[1,0,0]
    v_cvt_pk_bf16_f32 v120, v102, v103
    ds_write_addtid_b32 v120 offset:16512
    v_pk_mul_f32 v[118:119], v[106:107], v[100:101] op_sel:[0,0] op_sel_hi:[1,0]
    v_pk_fma_f32 v[106:107], v[106:107], v[100:101], v[118:119] op_sel:[1,1,0] op_sel_hi:[0,1,1] neg_hi:[1,0,0]
    v_cvt_pk_bf16_f32 v121, v106, v107
    ds_write_addtid_b32 v121 offset:18576
    v_pk_mul_f32 v[118:119], v[110:111], v[100:101] op_sel:[0,0] op_sel_hi:[1,0]
    v_pk_fma_f32 v[110:111], v[110:111], v[100:101], v[118:119] op_sel:[1,1,0] op_sel_hi:[0,1,1] neg_hi:[1,0,0]
    v_cvt_pk_bf16_f32 v122, v110, v111
    ds_write_addtid_b32 v122 offset:20640
    v_pk_mul_f32 v[118:119], v[114:115], v[100:101] op_sel:[0,0] op_sel_hi:[1,0]
    v_pk_fma_f32 v[114:115], v[114:115], v[100:101], v[118:119] op_sel:[1,1,0] op_sel_hi:[0,1,1] neg_hi:[1,0,0]
    v_cvt_pk_bf16_f32 v123, v114, v115
    ds_write_addtid_b32 v123 offset:22704
    v_pk_mul_f32 v[118:119], v[102:103], v[100:101] op_sel:[0,0] op_sel_hi:[1,0]
    v_pk_fma_f32 v[102:103], v[102:103], v[100:101], v[118:119] op_sel:[1,1,0] op_sel_hi:[0,1,1] neg_hi:[1,0,0]
    v_cvt_pk_bf16_f32 v120, v102, v103
    ds_write_addtid_b32 v120 offset:24768
    v_pk_mul_f32 v[118:119], v[110:111], v[100:101] op_sel:[0,0] op_sel_hi:[1,0]
    v_pk_fma_f32 v[110:111], v[110:111], v[100:101], v[118:119] op_sel:[1,1,0] op_sel_hi:[0,1,1] neg_hi:[1,0,0]
    v_cvt_pk_bf16_f32 v121, v110, v111
    ds_write_addtid_b32 v121 offset:26832
    v_pk_mul_f32 v[118:119], v[102:103], v[100:101] op_sel:[0,0] op_sel_hi:[1,0]
    v_pk_fma_f32 v[102:103], v[102:103], v[100:101], v[118:119] op_sel:[1,1,0] op_sel_hi:[0,1,1] neg_hi:[1,0,0]
    v_cvt_pk_bf16_f32 v122, v102, v103
    ds_write_addtid_b32 v122 offset:28896
    v_pk_mul_f32 v[118:119], v[110:111], v[100:101] op_sel:[0,0] op_sel_hi:[1,0]
    v_pk_fma_f32 v[110:111], v[110:111], v[100:101], v[118:119] op_sel:[1,1,0] op_sel_hi:[0,1,1] neg_hi:[1,0,0]
    v_cvt_pk_bf16_f32 v123, v110, v111
    ds_write_addtid_b32 v123 offset:30960
    v_pk_mul_f32 v[118:119], v[102:103], v[100:101] op_sel:[0,0] op_sel_hi:[1,0]
    v_pk_fma_f32 v[102:103], v[102:103], v[100:101], v[118:119] op_sel:[1,1,0] op_sel_hi:[0,1,1] neg_hi:[1,0,0]
    v_cvt_pk_bf16_f32 v120, v102, v103
    ds_write_addtid_b32 v120 offset:33024
    v_pk_mul_f32 v[118:119], v[102:103], v[100:101] op_sel:[0,0] op_sel_hi:[1,0]
    v_pk_fma_f32 v[102:103], v[102:103], v[100:101], v[118:119] op_sel:[1,1,0] op_sel_hi:[0,1,1] neg_hi:[1,0,0]
    v_cvt_pk_bf16_f32 v121, v102, v103
    ds_write_addtid_b32 v121 offset:35088
    v_pk_mul_f32 v[118:119], v[102:103], v[100:101] op_sel:[0,0] op_sel_hi:[1,0]
    v_pk_fma_f32 v[102:103], v[102:103], v[100:101], v[118:119] op_sel:[1,1,0] op_sel_hi:[0,1,1] neg_hi:[1,0,0]
    v_cvt_pk_bf16_f32 v122, v102, v103
    ds_write_addtid_b32 v122 offset:37152
    v_pk_mul_f32 v[118:119], v[102:103], v[100:101] op_sel:[0,0] op_sel_hi:[1,0]
    v_pk_fma_f32 v[102:103], v[102:103], v[100:101], v[118:119] op_sel:[1,1,0] op_sel_hi:[0,1,1] neg_hi:[1,0,0]
    v_cvt_pk_bf16_f32 v123, v102, v103
    ds_write_addtid_b32 v123 offset:39216
    v_pk_mul_f32 v[118:119], v[102:103], v[100:101] op_sel:[0,0] op_sel_hi:[1,0]
    v_pk_fma_f32 v[102:103], v[102:103], v[100:101], v[118:119] op_sel:[1,1,0] op_sel_hi:[0,1,1] neg_hi:[1,0,0]
    v_cvt_pk_bf16_f32 v120, v102, v103
    ds_write_addtid_b32 v120 offset:41280
    s_mov_b32 m0, s54
    v_mov_b32 v4, 0x00003f80
    v_cvt_pk_bf16_f32 v5, v98, v99
    ds_write_addtid_b32 v4 offset:0
    ds_write_addtid_b32 v5 offset:2064
    v_pk_mul_f32 v[118:119], v[98:99], v[98:99] op_sel:[0,0] op_sel_hi:[1,0]
    v_pk_fma_f32 v[102:103], v[98:99], v[98:99], v[118:119] op_sel:[1,1,0] op_sel_hi:[0,1,1] neg_lo:[1,0,0]
    v_cvt_pk_bf16_f32 v121, v102, v103
    ds_write_addtid_b32 v121 offset:4128
    v_pk_mul_f32 v[118:119], v[102:103], v[98:99] op_sel:[0,0] op_sel_hi:[1,0]
    v_pk_fma_f32 v[102:103], v[102:103], v[98:99], v[118:119] op_sel:[1,1,0] op_sel_hi:[0,1,1] neg_lo:[1,0,0]
    v_cvt_pk_bf16_f32 v122, v102, v103
    ds_write_addtid_b32 v122 offset:6192
    v_pk_mul_f32 v[118:119], v[102:103], v[98:99] op_sel:[0,0] op_sel_hi:[1,0]
    v_pk_fma_f32 v[102:103], v[102:103], v[98:99], v[118:119] op_sel:[1,1,0] op_sel_hi:[0,1,1] neg_lo:[1,0,0]
    v_cvt_pk_bf16_f32 v123, v102, v103
    ds_write_addtid_b32 v123 offset:8256
    v_pk_mul_f32 v[118:119], v[102:103], v[98:99] op_sel:[0,0] op_sel_hi:[1,0]
    v_pk_fma_f32 v[102:103], v[102:103], v[98:99], v[118:119] op_sel:[1,1,0] op_sel_hi:[0,1,1] neg_lo:[1,0,0]
    v_cvt_pk_bf16_f32 v120, v102, v103
    ds_write_addtid_b32 v120 offset:10320
    v_pk_mul_f32 v[118:119], v[102:103], v[98:99] op_sel:[0,0] op_sel_hi:[1,0]
    v_pk_fma_f32 v[102:103], v[102:103], v[98:99], v[118:119] op_sel:[1,1,0] op_sel_hi:[0,1,1] neg_lo:[1,0,0]
    v_cvt_pk_bf16_f32 v121, v102, v103
    ds_write_addtid_b32 v121 offset:12384
    v_pk_mul_f32 v[118:119], v[102:103], v[98:99] op_sel:[0,0] op_sel_hi:[1,0]
    v_pk_fma_f32 v[102:103], v[102:103], v[98:99], v[118:119] op_sel:[1,1,0] op_sel_hi:[0,1,1] neg_lo:[1,0,0]
    v_cvt_pk_bf16_f32 v122, v102, v103
    ds_write_addtid_b32 v122 offset:14448
    v_pk_mul_f32 v[118:119], v[102:103], v[98:99] op_sel:[0,0] op_sel_hi:[1,0]
    v_pk_fma_f32 v[102:103], v[102:103], v[98:99], v[118:119] op_sel:[1,1,0] op_sel_hi:[0,1,1] neg_lo:[1,0,0]
    v_cvt_pk_bf16_f32 v123, v102, v103
    ds_write_addtid_b32 v123 offset:16512
    v_pk_mul_f32 v[118:119], v[102:103], v[98:99] op_sel:[0,0] op_sel_hi:[1,0]
    v_pk_fma_f32 v[102:103], v[102:103], v[98:99], v[118:119] op_sel:[1,1,0] op_sel_hi:[0,1,1] neg_lo:[1,0,0]
    v_cvt_pk_bf16_f32 v120, v102, v103
    ds_write_addtid_b32 v120 offset:18576
    v_pk_mul_f32 v[118:119], v[102:103], v[98:99] op_sel:[0,0] op_sel_hi:[1,0]
    v_pk_fma_f32 v[102:103], v[102:103], v[98:99], v[118:119] op_sel:[1,1,0] op_sel_hi:[0,1,1] neg_lo:[1,0,0]
    v_cvt_pk_bf16_f32 v121, v102, v103
    ds_write_addtid_b32 v121 offset:20640
    v_pk_mul_f32 v[118:119], v[102:103], v[98:99] op_sel:[0,0] op_sel_hi:[1,0]
    v_pk_fma_f32 v[102:103], v[102:103], v[98:99], v[118:119] op_sel:[1,1,0] op_sel_hi:[0,1,1] neg_lo:[1,0,0]
    v_cvt_pk_bf16_f32 v122, v102, v103
    ds_write_addtid_b32 v122 offset:22704
    v_pk_mul_f32 v[118:119], v[102:103], v[98:99] op_sel:[0,0] op_sel_hi:[1,0]
    v_pk_fma_f32 v[102:103], v[102:103], v[98:99], v[118:119] op_sel:[1,1,0] op_sel_hi:[0,1,1] neg_lo:[1,0,0]
    v_cvt_pk_bf16_f32 v123, v102, v103
    ds_write_addtid_b32 v123 offset:24768
    v_pk_mul_f32 v[118:119], v[102:103], v[98:99] op_sel:[0,0] op_sel_hi:[1,0]
    v_pk_fma_f32 v[102:103], v[102:103], v[98:99], v[118:119] op_sel:[1,1,0] op_sel_hi:[0,1,1] neg_lo:[1,0,0]
    v_cvt_pk_bf16_f32 v120, v102, v103
    ds_write_addtid_b32 v120 offset:26832
    v_pk_mul_f32 v[118:119], v[102:103], v[98:99] op_sel:[0,0] op_sel_hi:[1,0]
    v_pk_fma_f32 v[102:103], v[102:103], v[98:99], v[118:119] op_sel:[1,1,0] op_sel_hi:[0,1,1] neg_lo:[1,0,0]
    v_cvt_pk_bf16_f32 v121, v102, v103
    ds_write_addtid_b32 v121 offset:28896
    v_pk_mul_f32 v[118:119], v[102:103], v[98:99] op_sel:[0,0] op_sel_hi:[1,0]
    v_pk_fma_f32 v[102:103], v[102:103], v[98:99], v[118:119] op_sel:[1,1,0] op_sel_hi:[0,1,1] neg_lo:[1,0,0]
    v_cvt_pk_bf16_f32 v122, v102, v103
    ds_write_addtid_b32 v122 offset:30960
    v_pk_mul_f32 v[118:119], v[102:103], v[98:99] op_sel:[0,0] op_sel_hi:[1,0]
    v_pk_fma_f32 v[102:103], v[102:103], v[98:99], v[118:119] op_sel:[1,1,0] op_sel_hi:[0,1,1] neg_lo:[1,0,0]
    v_cvt_pk_bf16_f32 v123, v102, v103
    ds_write_addtid_b32 v123 offset:33024
    v_pk_mul_f32 v[118:119], v[102:103], v[98:99] op_sel:[0,0] op_sel_hi:[1,0]
    v_pk_fma_f32 v[102:103], v[102:103], v[98:99], v[118:119] op_sel:[1,1,0] op_sel_hi:[0,1,1] neg_lo:[1,0,0]
    v_cvt_pk_bf16_f32 v120, v102, v103
    ds_write_addtid_b32 v120 offset:35088
    v_pk_mul_f32 v[118:119], v[102:103], v[98:99] op_sel:[0,0] op_sel_hi:[1,0]
    v_pk_fma_f32 v[102:103], v[102:103], v[98:99], v[118:119] op_sel:[1,1,0] op_sel_hi:[0,1,1] neg_lo:[1,0,0]
    v_cvt_pk_bf16_f32 v121, v102, v103
    ds_write_addtid_b32 v121 offset:37152
    s_cbranch_scc1 L_noh1
    global_load_dwordx4 v[36:39], v50, s[36:37] sc1
L_padB_p1:
    s_cbranch_execz L_padretB
    global_load_dwordx4 v[40:43], v51, s[36:37] sc1
L_noh1:
    v_pk_mul_f32 v[118:119], v[102:103], v[98:99] op_sel:[0,0] op_sel_hi:[1,0]
    v_pk_fma_f32 v[102:103], v[102:103], v[98:99], v[118:119] op_sel:[1,1,0] op_sel_hi:[0,1,1] neg_lo:[1,0,0]
    v_cvt_pk_bf16_f32 v122, v102, v103
    ds_write_addtid_b32 v122 offset:39216
    v_pk_mul_f32 v[118:119], v[102:103], v[98:99] op_sel:[0,0] op_sel_hi:[1,0]
    v_pk_fma_f32 v[102:103], v[102:103], v[98:99], v[118:119] op_sel:[1,1,0] op_sel_hi:[0,1,1] neg_lo:[1,0,0]
    v_cvt_pk_bf16_f32 v123, v102, v103
    ds_write_addtid_b32 v123 offset:41280
    v_pk_mul_f32 v[118:119], v[102:103], v[98:99] op_sel:[0,0] op_sel_hi:[1,0]
    v_pk_fma_f32 v[102:103], v[102:103], v[98:99], v[118:119] op_sel:[1,1,0] op_sel_hi:[0,1,1] neg_lo:[1,0,0]
    v_cvt_pk_bf16_f32 v120, v102, v103
    ds_write_addtid_b32 v120 offset:43344
    v_pk_mul_f32 v[118:119], v[102:103], v[98:99] op_sel:[0,0] op_sel_hi:[1,0]
    v_pk_fma_f32 v[102:103], v[102:103], v[98:99], v[118:119] op_sel:[1,1,0] op_sel_hi:[0,1,1] neg_lo:[1,0,0]
    v_cvt_pk_bf16_f32 v121, v102, v103
    ds_write_addtid_b32 v121 offset:45408
    v_pk_mul_f32 v[118:119], v[102:103], v[98:99] op_sel:[0,0] op_sel_hi:[1,0]
    v_pk_fma_f32 v[102:103], v[102:103], v[98:99], v[118:119] op_sel:[1,1,0] op_sel_hi:[0,1,1] neg_lo:[1,0,0]
    v_cvt_pk_bf16_f32 v122, v102, v103
    ds_write_addtid_b32 v122 offset:47472
    v_pk_mul_f32 v[118:119], v[102:103], v[98:99] op_sel:[0,0] op_sel_hi:[1,0]
    v_pk_fma_f32 v[102:103], v[102:103], v[98:99], v[118:119] op_sel:[1,1,0] op_sel_hi:[0,1,1] neg_lo:[1,0,0]
    v_cvt_pk_bf16_f32 v123, v102, v103
    ds_write_addtid_b32 v123 offset:49536
    v_pk_mul_f32 v[118:119], v[102:103], v[98:99] op_sel:[0,0] op_sel_hi:[1,0]
    v_pk_fma_f32 v[102:103], v[102:103], v[98:99], v[118:119] op_sel:[1,1,0] op_sel_hi:[0,1,1] neg_lo:[1,0,0]
    v_cvt_pk_bf16_f32 v120, v102, v103
    ds_write_addtid_b32 v120 offset:51600
    v_pk_mul_f32 v[118:119], v[102:103], v[98:99] op_sel:[0,0] op_sel_hi:[1,0]
    v_pk_fma_f32 v[102:103], v[102:103], v[98:99], v[118:119] op_sel:[1,1,0] op_sel_hi:[0,1,1] neg_lo:[1,0,0]
    v_cvt_pk_bf16_f32 v121, v102, v103
    ds_write_addtid_b32 v121 offset:53664
    v_pk_mul_f32 v[118:119], v[102:103], v[98:99] op_sel:[0,0] op_sel_hi:[1,0]
    v_pk_fma_f32 v[102:103], v[102:103], v[98:99], v[118:119] op_sel:[1,1,0] op_sel_hi:[0,1,1] neg_lo:[1,0,0]
    v_cvt_pk_bf16_f32 v122, v102, v103
    ds_write_addtid_b32 v122 offset:55728
    v_pk_mul_f32 v[118:119], v[102:103], v[98:99] op_sel:[0,0] op_sel_hi:[1,0]
    v_pk_fma_f32 v[102:103], v[102:103], v[98:99], v[118:119] op_sel:[1,1,0] op_sel_hi:[0,1,1] neg_lo:[1,0,0]
    v_cvt_pk_bf16_f32 v123, v102, v103
    ds_write_addtid_b32 v123 offset:57792
    v_pk_mul_f32 v[118:119], v[102:103], v[98:99] op_sel:[0,0] op_sel_hi:[1,0]
    v_pk_fma_f32 v[102:103], v[102:103], v[98:99], v[118:119] op_sel:[1,1,0] op_sel_hi:[0,1,1] neg_lo:[1,0,0]
    v_cvt_pk_bf16_f32 v120, v102, v103
    ds_write_addtid_b32 v120 offset:59856
    v_pk_mul_f32 v[118:119], v[102:103], v[98:99] op_sel:[0,0] op_sel_hi:[1,0]
    v_pk_fma_f32 v[102:103], v[102:103], v[98:99], v[118:119] op_sel:[1,1,0] op_sel_hi:[0,1,1] neg_lo:[1,0,0]
    v_cvt_pk_bf16_f32 v121, v102, v103
    ds_write_addtid_b32 v121 offset:61920
    v_pk_mul_f32 v[118:119], v[102:103], v[98:99] op_sel:[0,0] op_sel_hi:[1,0]
    v_pk_fma_f32 v[102:103], v[102:103], v[98:99], v[118:119] op_sel:[1,1,0] op_sel_hi:[0,1,1] neg_lo:[1,0,0]
    v_cvt_pk_bf16_f32 v122, v102, v103
    ds_write_addtid_b32 v122 offset:63984
    s_cbranch_scc0 L_chores
    ds_read_b128 v[124:127], v66 offset:0
    ds_read_b128 v[128:131], v67 offset:43344
    ds_read_b128 v[132:135], v66 offset:32
    ds_read_b128 v[136:139], v67 offset:43376
    ds_read_b128 v[140:143], v66 offset:64
    ds_read_b128 v[144:147], v67 offset:43408
    ds_read_b128 v[148:151], v66 offset:96
    ds_read_b128 v[152:155], v67 offset:43440
    global_load_dwordx4 v[68:71], v83, s[62:63] offset:0
    global_load_dwordx4 v[72:75], v83, s[62:63] offset:1024
    global_load_dwordx4 v[76:79], v83, s[62:63] offset:2048
    global_load_dwordx4 v[80:83], v83, s[62:63] offset:3072
    s_waitcnt vmcnt(4)
    s_waitcnt lgkmcnt(6)
    v_mfma_f32_32x32x16_bf16 v[104:119], v[124:127], v[128:131], 0
    ds_read_b128 v[156:159], v66 offset:128
    ds_read_b128 v[160:163], v67 offset:43472
    s_waitcnt lgkmcnt(6)
    v_mfma_f32_32x32x16_bf16 v[104:119], v[132:135], v[136:139], v[104:119]
    ds_read_b128 v[164:167], v66 offset:160
    ds_read_b128 v[168:171], v67 offset:43504
    s_waitcnt lgkmcnt(6)
    v_mfma_f32_32x32x16_bf16 v[104:119], v[140:143], v[144:147], v[104:119]
    ds_read_b128 v[124:127], v66 offset:192
    ds_read_b128 v[128:131], v67 offset:43536
    s_waitcnt lgkmcnt(6)
    v_mfma_f32_32x32x16_bf16 v[104:119], v[148:151], v[152:155], v[104:119]
    ds_read_b128 v[132:135], v66 offset:224
    ds_read_b128 v[136:139], v67 offset:43568
    s_waitcnt lgkmcnt(6)
    v_mfma_f32_32x32x16_bf16 v[104:119], v[156:159], v[160:163], v[104:119]
    s_barrier
    ds_read_b128 v[140:143], v66 offset:256
    ds_read_b128 v[144:147], v67 offset:43600
    s_waitcnt lgkmcnt(6)
    v_mfma_f32_32x32x16_bf16 v[104:119], v[164:167], v[168:171], v[104:119]
    ds_read_b128 v[148:151], v66 offset:288
    ds_read_b128 v[152:155], v67 offset:43632
    s_waitcnt lgkmcnt(6)
    v_mfma_f32_32x32x16_bf16 v[104:119], v[124:127], v[128:131], v[104:119]
    ds_read_b128 v[156:159], v66 offset:320
    ds_read_b128 v[160:163], v67 offset:43664
    s_waitcnt lgkmcnt(6)
    v_mfma_f32_32x32x16_bf16 v[104:119], v[132:135], v[136:139], v[104:119]
    ds_read_b128 v[164:167], v66 offset:352
    ds_read_b128 v[168:171], v67 offset:43696
    s_waitcnt lgkmcnt(6)
    v_mfma_f32_32x32x16_bf16 v[104:119], v[140:143], v[144:147], v[104:119]
    ds_read_b128 v[124:127], v66 offset:384
    ds_read_b128 v[128:131], v67 offset:43728
    s_waitcnt lgkmcnt(6)
    v_mfma_f32_32x32x16_bf16 v[104:119], v[148:151], v[152:155], v[104:119]
    ds_read_b128 v[132:135], v66 offset:416
    ds_read_b128 v[136:139], v67 offset:43760
    s_waitcnt lgkmcnt(6)
    v_mfma_f32_32x32x16_bf16 v[104:119], v[156:159], v[160:163], v[104:119]
    ds_read_b128 v[140:143], v66 offset:448
    ds_read_b128 v[144:147], v67 offset:43792
    s_waitcnt lgkmcnt(6)
    v_mfma_f32_32x32x16_bf16 v[104:119], v[164:167], v[168:171], v[104:119]
    ds_read_b128 v[148:151], v66 offset:480
    ds_read_b128 v[152:155], v67 offset:43824
    s_waitcnt lgkmcnt(6)
    v_mfma_f32_32x32x16_bf16 v[104:119], v[124:127], v[128:131], v[104:119]
    s_and_b32 s55, s40, 1
    s_lshl_b32 s53, s55, 10
    s_waitcnt lgkmcnt(4)
    v_mfma_f32_32x32x16_bf16 v[104:119], v[132:135], v[136:139], v[104:119]
    s_add_u32 s53, s53, 43344
    s_mul_i32 s55, s55, 8448
    s_waitcnt lgkmcnt(2)
    v_mfma_f32_32x32x16_bf16 v[104:119], v[140:143], v[144:147], v[104:119]
    s_add_u32 s54, s55, 109392
    v_add_u32_sdwa v96, s53, v32 dst_sel:DWORD dst_unused:UNUSED_PAD src0_sel:DWORD src1_sel:WORD_0
    s_waitcnt lgkmcnt(0)
    v_mfma_f32_32x32x16_bf16 v[104:119], v[148:151], v[152:155], v[104:119]
    v_add_u32_sdwa v97, s53, v32 dst_sel:DWORD dst_unused:UNUSED_PAD src0_sel:DWORD src1_sel:WORD_1
    v_add_u32_sdwa v98, s53, v33 dst_sel:DWORD dst_unused:UNUSED_PAD src0_sel:DWORD src1_sel:WORD_0
    v_add_u32_sdwa v99, s53, v33 dst_sel:DWORD dst_unused:UNUSED_PAD src0_sel:DWORD src1_sel:WORD_1
    v_add_u32_sdwa v100, s53, v34 dst_sel:DWORD dst_unused:UNUSED_PAD src0_sel:DWORD src1_sel:WORD_0
    v_add_u32_sdwa v101, s53, v34 dst_sel:DWORD dst_unused:UNUSED_PAD src0_sel:DWORD src1_sel:WORD_1
    v_add_u32_sdwa v102, s54, v35 dst_sel:DWORD dst_unused:UNUSED_PAD src0_sel:DWORD src1_sel:WORD_0
    s_and_b32 s53, s40, 6
    s_lshl_b32 s53, s53, 7
    s_add_u32 s55, s55, s53
    s_add_u32 s55, s55, 52240
    s_nop 1
    ds_write_addtid_b32 v104 offset:0
    ds_write_addtid_b32 v105 offset:2080
    ds_write_addtid_b32 v106 offset:4160
    ds_write_addtid_b32 v107 offset:6240
    ds_write_addtid_b32 v108 offset:8320
    ds_write_addtid_b32 v109 offset:10400
    ds_write_addtid_b32 v110 offset:12480
    ds_write_addtid_b32 v111 offset:14560
    ds_write_addtid_b32 v112 offset:16640
    ds_write_addtid_b32 v113 offset:18720
    ds_write_addtid_b32 v114 offset:20800
    ds_write_addtid_b32 v115 offset:22880
    s_bitcmp1_b32 s40, 1
    s_waitcnt lgkmcnt(0)
    s_barrier
    s_mov_b32 m0, s55
    ds_read2_b32 v[128:129], v96 offset0:0 offset1:128
    ds_read2_b32 v[130:131], v97 offset0:0 offset1:128
    ds_read2_b32 v[132:133], v98 offset0:0 offset1:128
    ds_read2_b32 v[134:135], v99 offset0:0 offset1:128
    ds_read2_b32 v[136:137], v100 offset0:0 offset1:128
    s_waitcnt lgkmcnt(2)
    v_add_f32 v96, v128, v129
    v_add_f32 v97, v130, v131
    v_add_f32 v98, v132, v133
    v_cvt_pk_bf16_f32 v122, v96, v97
    v_cvt_pk_bf16_f32 v123, v97, v98
    s_waitcnt lgkmcnt(0)
    v_add_f32 v99, v134, v135
    v_add_f32 v100, v136, v137
    v_cvt_pk_bf16_f32 v120, v99, v100
    ds_write_addtid_b32 v122 offset:57344
    ds_write_addtid_b32 v122 offset:61564
    ds_write_addtid_b32 v123 offset:59456
    ds_write_addtid_b32 v123 offset:63676
    ds_write_b32 v102, v120
    ds_write_b32 v102, v120 offset:4220
    s_cbranch_scc1 L_conv1
    s_branch L_conv0
L_chores:
    s_waitcnt lgkmcnt(0)
    s_barrier
    s_waitcnt vmcnt(2)
    s_cmp_lg_u32 s40, 7
    s_cbranch_scc1 L_ch1
    v_mov_b32 v124, -1
    v_mov_b32 v125, -1
    v_mov_b32 v126, -1
    v_mov_b32 v127, -1
    global_store_dwordx4 v62, v[124:127], s[36:37] offset:-4096 sc1
    global_store_dwordx4 v62, v[124:127], s[36:37] offset:-3072 sc1
    global_store_dwordx4 v62, v[124:127], s[36:37] offset:-2048 sc1
    global_store_dwordx4 v62, v[124:127], s[36:37] offset:-1024 sc1
    global_store_dwordx4 v62, v[124:127], s[36:37] offset:0 sc1
    global_store_dwordx4 v62, v[124:127], s[36:37] offset:1024 sc1
    global_store_dwordx4 v62, v[124:127], s[36:37] offset:2048 sc1
    global_store_dwordx4 v62, v[124:127], s[36:37] offset:3072 sc1
    global_store_dwordx4 v57, v[124:127], s[36:37] offset:0 sc1
    global_store_dwordx4 v57, v[124:127], s[36:37] offset:1024 sc1
L_ch1:
    v_and_b32 v28, s49, v28
    v_and_b32 v29, s49, v29
    v_and_b32 v30, s49, v30
    v_and_b32 v31, s49, v31
    s_and_b32 s55, s40, 1
    s_lshl_b32 s53, s55, 10
    s_add_u32 s53, s53, 43344
    s_mul_i32 s55, s55, 8448
    s_add_u32 s54, s55, 109392
    v_add_u32_sdwa v96, s53, v32 dst_sel:DWORD dst_unused:UNUSED_PAD src0_sel:DWORD src1_sel:WORD_0
    v_add_u32_sdwa v97, s53, v32 dst_sel:DWORD dst_unused:UNUSED_PAD src0_sel:DWORD src1_sel:WORD_1
    v_add_u32_sdwa v98, s53, v33 dst_sel:DWORD dst_unused:UNUSED_PAD src0_sel:DWORD src1_sel:WORD_0
    v_add_u32_sdwa v99, s53, v33 dst_sel:DWORD dst_unused:UNUSED_PAD src0_sel:DWORD src1_sel:WORD_1
    v_add_u32_sdwa v100, s53, v34 dst_sel:DWORD dst_unused:UNUSED_PAD src0_sel:DWORD src1_sel:WORD_0
    v_add_u32_sdwa v101, s53, v34 dst_sel:DWORD dst_unused:UNUSED_PAD src0_sel:DWORD src1_sel:WORD_1
    v_add_u32_sdwa v102, s54, v35 dst_sel:DWORD dst_unused:UNUSED_PAD src0_sel:DWORD src1_sel:WORD_0
    s_and_b32 s53, s40, 6
    s_lshl_b32 s53, s53, 7
    s_add_u32 s55, s55, s53
    s_add_u32 s55, s55, 52240
    s_waitcnt vmcnt(10)
    s_cmp_eq_u32 s40, 7
    s_cbranch_scc1 L_ch2
    s_waitcnt vmcnt(0)
L_ch2:
    v_xor_b32 v104, v36, v28
    v_xor_b32 v105, v37, v29
    v_xor_b32 v106, v38, v30
    v_xor_b32 v107, v39, v31
    v_xor_b32 v108, v40, v28
    v_xor_b32 v109, v41, v29
    v_xor_b32 v110, v42, v30
    v_xor_b32 v111, v43, v31
    v_or3_b32 v4, v104, v105, v106
    v_or3_b32 v5, v107, v108, v109
    v_or3_b32 v4, v4, v110, v111
    v_bitop3_b32 v4, v4, v5, s49 bitop3:0xa8
    v_cmp_ne_u32 vcc, 0, v4
    s_cbranch_vccz L_ch3
    global_load_dwordx4 v[36:39], v50, s[36:37] sc1
    global_load_dwordx4 v[40:43], v51, s[36:37] sc1
    s_mov_b32 s101, 1
    s_branch L_b2
L_ch3:
    ds_write_b128 v55, v[104:107]
    ds_write_b128 v55, v[108:111] offset:2048
L_b2:
    s_cmp_ge_u32 s40, 6
    s_waitcnt lgkmcnt(0)
    s_barrier
    s_mov_b32 m0, s55
    ds_read2_b32 v[128:129], v96 offset0:0 offset1:128
    ds_read2_b32 v[130:131], v97 offset0:0 offset1:128
    ds_read2_b32 v[132:133], v98 offset0:0 offset1:128
    s_cbranch_scc1 L_exp0
    s_mov_b64 exec, 0xf
    ds_read2_b32 v[134:135], v99 offset0:0 offset1:128
    ds_read2_b32 v[136:137], v100 offset0:0 offset1:128
    ds_read2_b32 v[138:139], v101 offset0:0 offset1:128
    s_mov_b64 exec, -1
    s_waitcnt lgkmcnt(3)
    s_branch L_exp1
L_exp0:
    s_waitcnt lgkmcnt(0)
L_exp1:
    v_add_f32 v96, v128, v129
    v_add_f32 v97, v130, v131
    v_add_f32 v98, v132, v133
    v_cvt_pk_bf16_f32 v122, v96, v97
    v_cvt_pk_bf16_f32 v123, v97, v98
    ds_write_addtid_b32 v122 offset:57344
    ds_write_addtid_b32 v122 offset:61564
    ds_write_addtid_b32 v123 offset:59456
    ds_write_addtid_b32 v123 offset:63676
    s_cbranch_scc1 L_exp2
    s_mov_b64 exec, 0xf
    s_waitcnt lgkmcnt(4)
    v_add_f32 v99, v134, v135
    v_add_f32 v100, v136, v137
    v_add_f32 v101, v138, v139
    v_cvt_pk_bf16_f32 v120, v99, v100
    v_cvt_pk_bf16_f32 v121, v100, v101
    ds_write_b32 v102, v120
    ds_write_b32 v102, v120 offset:4220
    ds_write_b32 v102, v121 offset:2112
    ds_write_b32 v102, v121 offset:6332
    s_mov_b64 exec, -1
L_exp2:
    s_cmp_eq_u32 s101, 0
    s_cbranch_scc1 L_b3
L_hop1:
    s_waitcnt vmcnt(0)
    v_xor_b32 v104, v36, v28
    v_xor_b32 v105, v37, v29
    v_xor_b32 v106, v38, v30
    v_xor_b32 v107, v39, v31
    v_xor_b32 v108, v40, v28
    v_xor_b32 v109, v41, v29
    v_xor_b32 v110, v42, v30
    v_xor_b32 v111, v43, v31
    v_or3_b32 v4, v104, v105, v106
    v_or3_b32 v5, v107, v108, v109
    v_or3_b32 v4, v4, v110, v111
    v_bitop3_b32 v4, v4, v5, s49 bitop3:0xa8
    v_cmp_ne_u32 vcc, 0, v4
    s_cbranch_vccz L_hop1_ok
    global_load_dwordx4 v[36:39], v50, s[36:37] sc1
    global_load_dwordx4 v[40:43], v51, s[36:37] sc1
    s_add_u32 s58, s58, 1
    s_cmp_lt_u32 s58, 65536
    s_cbranch_scc1 L_hop1
L_hop1_ok:
    ds_write_b128 v55, v[104:107]
    ds_write_b128 v55, v[108:111] offset:2048
L_b3:
    s_cmp_lg_u32 s40, 7
    s_waitcnt lgkmcnt(0)
    s_barrier
    s_cbranch_scc1 L_nofl
    s_waitcnt vmcnt(0)
    s_lshl_b32 s53, s38, 6
    s_add_u32 s53, s53, 4063232
    v_lshl_add_u32 v4, v1, 2, s53
    v_mov_b32 v5, s42
    s_mov_b64 exec, 0xffff
    global_store_dword v4, v5, s[36:37] sc1
    s_mov_b64 exec, -1
L_nofl:
    s_cmp_eq_u32 s44, 7
    s_cbranch_scc1 L_nowpfb
    global_load_dword v255, v56, s[22:23]
L_nowpfb:
    s_mov_b64 exec, 0
    s_cmp_eq_u32 s40, 4
    s_cbranch_scc1 L_padC_0
    s_cmp_eq_u32 s40, 5
    s_cbranch_scc1 L_padC_p3
    s_cmp_eq_u32 s40, 6
    s_cbranch_scc1 L_padC_1
L_padretC:
    s_mov_b64 exec, -1
    s_cmp_eq_u32 s40, 7
    s_barrier
    s_cbranch_scc1 L_flags
    s_branch L_cvdone
L_conv1:
L_padB_0:
    s_cbranch_execz L_padretB
    s_waitcnt vmcnt(0) lgkmcnt(0)
    s_barrier
    ds_read_b64 v[120:121], v60 offset:1088
    ds_read_b64 v[122:123], v60 offset:1096
    ds_read_b128 v[124:127], v61 offset:1408
    ds_read_b64 v[128:129], v60 offset:576
    ds_read_b64 v[130:131], v60 offset:584
    ds_read_b128 v[132:135], v61 offset:896
    ds_read_b128 v[136:139], v61 offset:1920
    s_waitcnt lgkmcnt(0)
    v_mfma_f32_16x16x32_bf16 v[96:99], v[120:123], v[124:127], 0
    ds_read_b128 v[140:143], v64 offset:432
    ds_read_b128 v[144:147], v61 offset:2432
    v_mfma_f32_16x16x32_bf16 v[96:99], v[128:131], v[132:135], v[96:99]
    ds_read_b128 v[148:151], v61 offset:2944
    ds_read_b64 v[152:153], v60 offset:1024
    v_mfma_f32_16x16x32_bf16 v[100:103], v[120:123], v[136:139], 0
    ds_read_b64 v[154:155], v60 offset:1032
    ds_read_b128 v[156:159], v61 offset:1344
    v_mfma_f32_16x16x32_bf16 v[100:103], v[128:131], v[124:127], v[100:103]
    ds_read_b64 v[160:161], v60 offset:512
    s_waitcnt lgkmcnt(5)
    v_mfma_f32_16x16x32_bf16 v[164:167], v[140:143], v[68:71], 0
    ds_read_b64 v[162:163], v60 offset:520
    ds_read_b128 v[168:171], v61 offset:832
    v_mfma_f32_16x16x32_bf16 v[172:175], v[140:143], v[72:75], 0
    ds_read_b128 v[176:179], v61 offset:1856
    ds_read_b128 v[180:183], v64 offset:688
    v_mfma_f32_16x16x32_bf16 v[104:107], v[120:123], v[144:147], 0
    ds_read_b128 v[184:187], v61 offset:2368
    v_mfma_f32_16x16x32_bf16 v[104:107], v[128:131], v[136:139], v[104:107]
    s_waitcnt lgkmcnt(3)
    v_mfma_f32_16x16x32_bf16 v[108:111], v[120:123], v[148:151], 0
    ds_read_b128 v[188:191], v61 offset:2880
    v_mfma_f32_16x16x32_bf16 v[108:111], v[128:131], v[144:147], v[108:111]
    v_cvt_pk_bf16_f32 v164, v164, v172
    v_cvt_pk_bf16_f32 v165, v165, v173
    v_mfma_f32_16x16x32_bf16 v[96:99], v[152:155], v[156:159], v[96:99]
    v_cvt_pk_bf16_f32 v166, v166, v174
    v_cvt_pk_bf16_f32 v167, v167, v175
    v_mfma_f32_16x16x32_bf16 v[96:99], v[160:163], v[168:171], v[96:99]
    ds_read_b64 v[192:193], v62 offset:1504
    s_waitcnt lgkmcnt(2)
    v_mfma_f32_16x16x32_bf16 v[100:103], v[152:155], v[176:179], v[100:103]
    ds_read_b64 v[194:195], v62 offset:1512
    ds_read_b64 v[196:197], v62 offset:1376
    v_mfma_f32_16x16x32_bf16 v[100:103], v[160:163], v[156:159], v[100:103]
    ds_read_b64 v[198:199], v62 offset:1384
    ds_read_b64 v[200:201], v62 offset:1248
    v_mfma_f32_16x16x32_bf16 v[204:207], v[180:183], v[68:71], 0
    ds_read_b64 v[202:203], v62 offset:1256
    ds_read_b64 v[208:209], v60 offset:960
    v_mfma_f32_16x16x32_bf16 v[212:215], v[180:183], v[72:75], 0
    ds_read_b64 v[210:211], v60 offset:968
    ds_read_b128 v[216:219], v61 offset:1280
    v_mfma_f32_16x16x32_bf16 v[104:107], v[152:155], v[184:187], v[104:107]
    ds_read_b64 v[220:221], v60 offset:448
    ds_read_b64 v[222:223], v60 offset:456
    v_mfma_f32_16x16x32_bf16 v[104:107], v[160:163], v[176:179], v[104:107]
    ds_read_b128 v[224:227], v61 offset:768
    s_waitcnt lgkmcnt(8)
    v_mfma_f32_16x16x32_bf16 v[108:111], v[152:155], v[188:191], v[108:111]
    ds_read_b128 v[228:231], v61 offset:1792
    ds_read_b128 v[232:235], v64 offset:944
    v_mfma_f32_16x16x32_bf16 v[108:111], v[160:163], v[184:187], v[108:111]
    v_cvt_pk_bf16_f32 v204, v204, v212
    v_cvt_pk_bf16_f32 v205, v205, v213
    v_mfma_f32_16x16x32_bf16 v[96:99], v[164:167], v[192:195], v[96:99]
    v_cvt_pk_bf16_f32 v206, v206, v214
    v_cvt_pk_bf16_f32 v207, v207, v215
    v_mfma_f32_16x16x32_bf16 v[100:103], v[164:167], v[196:199], v[100:103]
    ds_read_b128 v[236:239], v61 offset:2304
    s_waitcnt lgkmcnt(2)
    v_mfma_f32_16x16x32_bf16 v[104:107], v[164:167], v[200:203], v[104:107]
    ds_read_b128 v[240:243], v61 offset:2816
    v_mfma_f32_16x16x32_bf16 v[96:99], v[208:211], v[216:219], v[96:99]
    ds_read_b64 v[244:245], v62 offset:1568
    ds_read_b64 v[246:247], v62 offset:1576
    v_mfma_f32_16x16x32_bf16 v[96:99], v[220:223], v[224:227], v[96:99]
    ds_read_b64 v[248:249], v62 offset:1440
    ds_read_b64 v[250:251], v62 offset:1448
    v_mfma_f32_16x16x32_bf16 v[100:103], v[208:211], v[228:231], v[100:103]
    ds_read_b64 v[252:253], v62 offset:1312
    ds_read_b64 v[254:255], v62 offset:1320
    v_mfma_f32_16x16x32_bf16 v[100:103], v[220:223], v[216:219], v[100:103]
    ds_read_b64 v[132:133], v60 offset:1152
    s_waitcnt lgkmcnt(8)
    v_mfma_f32_16x16x32_bf16 v[124:127], v[232:235], v[68:71], 0
    ds_read_b64 v[134:135], v60 offset:1160
    ds_read_b128 v[140:143], v61 offset:1472
    v_mfma_f32_16x16x32_bf16 v[136:139], v[232:235], v[72:75], 0
    ds_read_b64 v[120:121], v60 offset:640
    ds_read_b64 v[122:123], v60 offset:648
    v_mfma_f32_16x16x32_bf16 v[104:107], v[208:211], v[236:239], v[104:107]
    ds_read_b128 v[148:151], v61 offset:960
    ds_read_b128 v[128:131], v61 offset:1984
    v_mfma_f32_16x16x32_bf16 v[104:107], v[220:223], v[228:231], v[104:107]
    ds_read_b128 v[144:147], v61 offset:432
    s_waitcnt lgkmcnt(8)
    v_mfma_f32_16x16x32_bf16 v[108:111], v[208:211], v[240:243], v[108:111]
    ds_read_b128 v[172:175], v61 offset:448
    v_mfma_f32_16x16x32_bf16 v[108:111], v[220:223], v[236:239], v[108:111]
    v_cvt_pk_bf16_f32 v124, v124, v136
    v_cvt_pk_bf16_f32 v125, v125, v137
    v_mfma_f32_16x16x32_bf16 v[96:99], v[204:207], v[244:247], v[96:99]
    v_cvt_pk_bf16_f32 v126, v126, v138
    v_cvt_pk_bf16_f32 v127, v127, v139
    v_mfma_f32_16x16x32_bf16 v[100:103], v[204:207], v[248:251], v[100:103]
    ds_read_b128 v[168:171], v61 offset:2496
    ds_read_b128 v[156:159], v61 offset:3008
    v_mfma_f32_16x16x32_bf16 v[104:107], v[204:207], v[252:255], v[104:107]
    s_waitcnt lgkmcnt(3)
    v_mfma_f32_16x16x32_bf16 v[96:99], v[132:135], v[140:143], v[96:99]
    ds_read_b128 v[180:183], v61 offset:944
    v_mfma_f32_16x16x32_bf16 v[96:99], v[120:123], v[148:151], v[96:99]
    v_mfma_f32_16x16x32_bf16 v[100:103], v[132:135], v[128:131], v[100:103]
    ds_read_b64 v[176:177], v60 offset:128
    ds_read_b64 v[178:179], v60 offset:136
    v_mfma_f32_16x16x32_bf16 v[100:103], v[120:123], v[140:143], v[100:103]
    v_mfma_f32_16x16x32_bf16 v[152:155], v[144:147], v[76:79], 0
    s_waitcnt lgkmcnt(3)
    v_mfma_f32_16x16x32_bf16 v[188:191], v[172:175], v[80:83], 0
    v_mfma_f32_16x16x32_bf16 v[104:107], v[132:135], v[168:171], v[104:107]
    ds_read_b64 v[160:161], v60 offset:0
    ds_read_b64 v[162:163], v60 offset:8
    v_mfma_f32_16x16x32_bf16 v[104:107], v[120:123], v[128:131], v[104:107]
    v_mfma_f32_16x16x32_bf16 v[108:111], v[132:135], v[156:159], v[108:111]
    v_mfma_f32_16x16x32_bf16 v[108:111], v[120:123], v[168:171], v[108:111]
    s_nop 1
    v_cvt_pk_bf16_f32 v152, v152, v188
    s_waitcnt lgkmcnt(2)
    v_mfma_f32_16x16x32_bf16 v[184:187], v[180:183], v[76:79], 0
    v_cvt_pk_bf16_f32 v153, v153, v189
    v_cvt_pk_bf16_f32 v154, v154, v190
    v_mfma_f32_16x16x32_bf16 v[212:215], v[148:151], v[80:83], 0
    v_cvt_pk_bf16_f32 v155, v155, v191
    ds_read_b64 v[164:165], v60 offset:896
    v_mfma_f32_16x16x32_bf16 v[96:99], v[176:179], v[172:175], v[96:99]
    ds_read_b64 v[166:167], v60 offset:904
    ds_read_b128 v[224:227], v61 offset:1216
    v_mfma_f32_16x16x32_bf16 v[100:103], v[176:179], v[148:151], v[100:103]
    ds_read_b64 v[216:217], v60 offset:384
    ds_read_b64 v[218:219], v60 offset:392
    v_mfma_f32_16x16x32_bf16 v[104:107], v[176:179], v[140:143], v[104:107]
    ds_read_b128 v[232:235], v61 offset:704
    ds_read_b128 v[228:231], v61 offset:1728
    v_mfma_f32_16x16x32_bf16 v[108:111], v[176:179], v[128:131], v[108:111]
    v_cvt_pk_bf16_f32 v184, v184, v212
    s_waitcnt lgkmcnt(7)
    v_mfma_f32_16x16x32_bf16 v[104:107], v[160:163], v[172:175], v[104:107]
    v_cvt_pk_bf16_f32 v185, v185, v213
    v_cvt_pk_bf16_f32 v186, v186, v214
    v_mfma_f32_16x16x32_bf16 v[108:111], v[160:163], v[148:151], v[108:111]
    ds_read_b128 v[208:211], v64 offset:1200
    v_cvt_pk_bf16_f32 v187, v187, v215
    v_mfma_f32_16x16x32_bf16 v[100:103], v[124:127], v[192:195], v[100:103]
    ds_read_b128 v[240:243], v61 offset:2240
    v_mfma_f32_16x16x32_bf16 v[104:107], v[124:127], v[196:199], v[104:107]
    ds_read_b128 v[220:223], v61 offset:2752
    v_mfma_f32_16x16x32_bf16 v[108:111], v[124:127], v[200:203], v[108:111]
    s_waitcnt lgkmcnt(2)
    v_mfma_f32_16x16x32_bf16 v[96:99], v[164:167], v[224:227], v[96:99]
    ds_read_b64 v[236:237], v63 offset:1952
    ds_read_b64 v[238:239], v63 offset:1960
    v_mfma_f32_16x16x32_bf16 v[96:99], v[216:219], v[232:235], v[96:99]
    ds_read_b64 v[136:137], v63 offset:1888
    ds_read_b64 v[138:139], v63 offset:1896
    v_mfma_f32_16x16x32_bf16 v[100:103], v[164:167], v[228:231], v[100:103]
    v_mfma_f32_16x16x32_bf16 v[100:103], v[216:219], v[224:227], v[100:103]
    ds_read_b64 v[204:205], v60 offset:832
    ds_read_b64 v[206:207], v60 offset:840
    v_mfma_f32_16x16x32_bf16 v[144:147], v[208:211], v[68:71], 0
    ds_read_b128 v[132:135], v61 offset:1152
    ds_read_b64 v[156:157], v60 offset:320
    v_mfma_f32_16x16x32_bf16 v[120:123], v[208:211], v[72:75], 0
    ds_read_b64 v[158:159], v60 offset:328
    s_waitcnt lgkmcnt(7)
    v_mfma_f32_16x16x32_bf16 v[104:107], v[164:167], v[240:243], v[104:107]
    s_barrier
    ds_read_b128 v[168:171], v61 offset:640
    v_mfma_f32_16x16x32_bf16 v[104:107], v[216:219], v[228:231], v[104:107]
    ds_read_b128 v[180:183], v61 offset:1664
    ds_read_b128 v[188:191], v64 offset:1456
    v_mfma_f32_16x16x32_bf16 v[108:111], v[164:167], v[220:223], v[108:111]
    v_mfma_f32_16x16x32_bf16 v[108:111], v[216:219], v[240:243], v[108:111]
    v_cvt_pk_bf16_f32 v144, v144, v120
    v_cvt_pk_bf16_f32 v145, v145, v121
    v_mfma_f32_16x16x32_bf16 v[104:107], v[152:155], v[236:239], v[104:107]
    v_cvt_pk_bf16_f32 v146, v146, v122
    s_waitcnt lgkmcnt(1)
    v_mfma_f32_16x16x32_bf16 v[108:111], v[152:155], v[136:139], v[108:111]
    ds_read_b128 v[140:143], v61 offset:2176
    v_cvt_pk_bf16_f32 v147, v147, v123
    v_mfma_f32_16x16x32_bf16 v[108:111], v[184:187], v[236:239], v[108:111]
    ds_read_b128 v[176:179], v61 offset:2688
    v_mfma_f32_16x16x32_bf16 v[96:99], v[204:207], v[132:135], v[96:99]
    v_mfma_f32_16x16x32_bf16 v[96:99], v[156:159], v[168:171], v[96:99]
    v_mfma_f32_16x16x32_bf16 v[100:103], v[204:207], v[180:183], v[100:103]
    v_mfma_f32_16x16x32_bf16 v[100:103], v[156:159], v[132:135], v[100:103]
    ds_read_b64 v[128:129], v60 offset:768
    s_waitcnt lgkmcnt(2)
    v_mfma_f32_16x16x32_bf16 v[172:175], v[188:191], v[68:71], 0
    ds_read_b64 v[130:131], v60 offset:776
    ds_read_b128 v[160:163], v61 offset:1088
    v_mfma_f32_16x16x32_bf16 v[148:151], v[188:191], v[72:75], 0
    ds_read_b64 v[212:213], v60 offset:256
    ds_read_b64 v[214:215], v60 offset:264
    v_mfma_f32_16x16x32_bf16 v[104:107], v[204:207], v[140:143], v[104:107]
    ds_read_b128 v[124:127], v61 offset:576
    ds_read_b128 v[200:203], v64 offset:1712
    v_mfma_f32_16x16x32_bf16 v[104:107], v[156:159], v[180:183], v[104:107]
    ds_read_b128 v[232:235], v61 offset:1600
    s_waitcnt lgkmcnt(8)
    v_mfma_f32_16x16x32_bf16 v[108:111], v[204:207], v[176:179], v[108:111]
    v_mfma_f32_16x16x32_bf16 v[108:111], v[156:159], v[140:143], v[108:111]
    v_cvt_pk_bf16_f32 v172, v172, v148
    v_cvt_pk_bf16_f32 v173, v173, v149
    v_mfma_f32_16x16x32_bf16 v[100:103], v[144:147], v[244:247], v[100:103]
    v_cvt_pk_bf16_f32 v174, v174, v150
    v_cvt_pk_bf16_f32 v175, v175, v151
    v_mfma_f32_16x16x32_bf16 v[104:107], v[144:147], v[248:251], v[104:107]
    ds_read_b128 v[224:227], v64 offset:2224
    ds_read_b128 v[208:211], v61 offset:2112
    v_mfma_f32_16x16x32_bf16 v[108:111], v[144:147], v[252:255], v[108:111]
    s_waitcnt lgkmcnt(2)
    v_mfma_f32_16x16x32_bf16 v[96:99], v[128:131], v[160:163], v[96:99]
    ds_read_b128 v[228:231], v61 offset:2624
    v_mfma_f32_16x16x32_bf16 v[96:99], v[212:215], v[124:127], v[96:99]
    v_mfma_f32_16x16x32_bf16 v[164:167], v[200:203], v[68:71], 0
    v_mfma_f32_16x16x32_bf16 v[220:223], v[200:203], v[72:75], 0
    v_mfma_f32_16x16x32_bf16 v[100:103], v[128:131], v[232:235], v[100:103]
    ds_read_b64 v[216:217], v60 offset:704
    ds_read_b64 v[218:219], v60 offset:712
    v_mfma_f32_16x16x32_bf16 v[100:103], v[212:215], v[160:163], v[100:103]
    ds_read_b128 v[240:243], v61 offset:1024
    s_waitcnt lgkmcnt(3)
    v_mfma_f32_16x16x32_bf16 v[152:155], v[224:227], v[68:71], 0
    ds_read_b64 v[136:137], v60 offset:192
    ds_read_b64 v[138:139], v60 offset:200
    v_mfma_f32_16x16x32_bf16 v[120:123], v[224:227], v[72:75], 0
    ds_read_b128 v[184:187], v61 offset:512
    v_cvt_pk_bf16_f32 v164, v164, v220
    v_mfma_f32_16x16x32_bf16 v[104:107], v[128:131], v[208:211], v[104:107]
    ds_read_b128 v[236:239], v61 offset:1536
    v_cvt_pk_bf16_f32 v165, v165, v221
    v_mfma_f32_16x16x32_bf16 v[104:107], v[212:215], v[232:235], v[104:107]
    v_cvt_pk_bf16_f32 v166, v166, v222
    v_cvt_pk_bf16_f32 v167, v167, v223
    v_mfma_f32_16x16x32_bf16 v[108:111], v[128:131], v[228:231], v[108:111]
    ds_read_b128 v[168:171], v64 offset:1968
    ds_read_b128 v[132:135], v61 offset:2048
    v_mfma_f32_16x16x32_bf16 v[108:111], v[212:215], v[208:211], v[108:111]
    v_cvt_pk_bf16_f32 v152, v152, v120
    v_cvt_pk_bf16_f32 v153, v153, v121
L_padB_p2:
    s_cbranch_execz L_padretB
    v_mfma_f32_16x16x32_bf16 v[104:107], v[172:175], v[192:195], v[104:107]
    v_cvt_pk_bf16_f32 v154, v154, v122
    v_cvt_pk_bf16_f32 v155, v155, v123
    v_mfma_f32_16x16x32_bf16 v[108:111], v[172:175], v[196:199], v[108:111]
    ds_read_b128 v[188:191], v61 offset:2560
    s_waitcnt lgkmcnt(2)
    v_mfma_f32_16x16x32_bf16 v[96:99], v[216:219], v[240:243], v[96:99]
    v_mfma_f32_16x16x32_bf16 v[96:99], v[136:139], v[184:187], v[96:99]
    v_mfma_f32_16x16x32_bf16 v[100:103], v[216:219], v[236:239], v[100:103]
    v_mfma_f32_16x16x32_bf16 v[100:103], v[136:139], v[240:243], v[100:103]
    v_mfma_f32_16x16x32_bf16 v[180:183], v[168:171], v[68:71], 0
    v_mfma_f32_16x16x32_bf16 v[204:207], v[168:171], v[72:75], 0
    s_waitcnt lgkmcnt(0)
    v_mfma_f32_16x16x32_bf16 v[104:107], v[216:219], v[132:135], v[104:107]
    v_mfma_f32_16x16x32_bf16 v[104:107], v[136:139], v[236:239], v[104:107]
    v_mfma_f32_16x16x32_bf16 v[108:111], v[216:219], v[188:191], v[108:111]
    v_mfma_f32_16x16x32_bf16 v[108:111], v[136:139], v[132:135], v[108:111]
    s_nop 2
    v_cvt_pk_bf16_f32 v180, v180, v204
    v_cvt_pk_bf16_f32 v181, v181, v205
    v_mfma_f32_16x16x32_bf16 v[104:107], v[164:167], v[244:247], v[104:107]
    v_cvt_pk_bf16_f32 v182, v182, v206
    v_cvt_pk_bf16_f32 v183, v183, v207
    v_mfma_f32_16x16x32_bf16 v[108:111], v[164:167], v[248:251], v[108:111]
    v_cvt_pk_bf16_f32 v112, v96, v97
    v_cvt_pk_bf16_f32 v114, v100, v101
    v_mfma_f32_16x16x32_bf16 v[108:111], v[152:155], v[244:247], v[108:111]
    v_cvt_pk_bf16_f32 v113, v98, v99
    v_cvt_pk_bf16_f32 v115, v102, v103
    v_mfma_f32_16x16x32_bf16 v[108:111], v[180:183], v[192:195], v[108:111]
    v_permlane16_swap_b32 v112, v114
    v_permlane16_swap_b32 v113, v115
    global_store_dwordx4 v65, v[112:115], s[36:37] offset:-1024 sc1
    v_cvt_pk_bf16_f32 v116, v104, v105
    s_nop 3
    v_cvt_pk_bf16_f32 v118, v108, v109
    v_cvt_pk_bf16_f32 v117, v106, v107
    v_cvt_pk_bf16_f32 v119, v110, v111
    v_permlane16_swap_b32 v116, v118
    s_nop 0
    v_permlane16_swap_b32 v117, v119
    global_store_dwordx4 v65, v[116:119], s[36:37] offset:1024 sc1
    s_branch L_cvdone
L_conv0:
L_padB_1:
    s_cbranch_execz L_padretB
    s_waitcnt vmcnt(0) lgkmcnt(0)
    s_barrier
    ds_read_b64 v[120:121], v60 offset:1088
    ds_read_b64 v[122:123], v60 offset:1096
    ds_read_b128 v[124:127], v61 offset:384
    ds_read_b128 v[128:131], v61 offset:896
    ds_read_b64 v[132:133], v60 offset:576
    ds_read_b64 v[134:135], v60 offset:584
    ds_read_b128 v[136:139], v64 offset:1456
    s_waitcnt lgkmcnt(0)
    v_mfma_f32_16x16x32_bf16 v[96:99], v[120:123], v[124:127], 0
    ds_read_b128 v[140:143], v61 offset:3456
    ds_read_b128 v[144:147], v61 offset:2944
    v_mfma_f32_16x16x32_bf16 v[100:103], v[120:123], v[128:131], 0
    ds_read_b128 v[148:151], v61 offset:3968
    ds_read_b64 v[152:153], v60 offset:1024
    v_mfma_f32_16x16x32_bf16 v[100:103], v[132:135], v[124:127], v[100:103]
    ds_read_b64 v[154:155], v60 offset:1032
    ds_read_b128 v[156:159], v61 offset:320
    v_mfma_f32_16x16x32_bf16 v[160:163], v[136:139], v[68:71], 0
    ds_read_b128 v[164:167], v61 offset:832
    ds_read_b64 v[168:169], v60 offset:512
    v_mfma_f32_16x16x32_bf16 v[172:175], v[136:139], v[72:75], 0
    ds_read_b64 v[170:171], v60 offset:520
    s_waitcnt lgkmcnt(5)
    v_mfma_f32_16x16x32_bf16 v[104:107], v[120:123], v[140:143], 0
    ds_read_b128 v[176:179], v64 offset:1712
    ds_read_b128 v[180:183], v61 offset:3392
    v_mfma_f32_16x16x32_bf16 v[104:107], v[132:135], v[144:147], v[104:107]
    ds_read_b128 v[184:187], v61 offset:2880
    ds_read_b128 v[188:191], v61 offset:3904
    v_mfma_f32_16x16x32_bf16 v[108:111], v[120:123], v[148:151], 0
    v_mfma_f32_16x16x32_bf16 v[108:111], v[132:135], v[140:143], v[108:111]
    v_cvt_pk_bf16_f32 v160, v160, v172
    s_waitcnt lgkmcnt(3)
    v_mfma_f32_16x16x32_bf16 v[96:99], v[152:155], v[156:159], v[96:99]
    v_cvt_pk_bf16_f32 v161, v161, v173
    v_cvt_pk_bf16_f32 v162, v162, v174
    v_mfma_f32_16x16x32_bf16 v[100:103], v[152:155], v[164:167], v[100:103]
    ds_read_b64 v[192:193], v62 offset:1248
    ds_read_b64 v[194:195], v62 offset:1256
    v_mfma_f32_16x16x32_bf16 v[100:103], v[168:171], v[156:159], v[100:103]
    ds_read_b64 v[196:197], v60 offset:960
    ds_read_b64 v[198:199], v60 offset:968
    v_mfma_f32_16x16x32_bf16 v[200:203], v[176:179], v[68:71], 0
    ds_read_b128 v[204:207], v61 offset:256
    ds_read_b128 v[208:211], v61 offset:768
    v_mfma_f32_16x16x32_bf16 v[212:215], v[176:179], v[72:75], 0
    ds_read_b64 v[216:217], v60 offset:448
    s_waitcnt lgkmcnt(5)
    v_mfma_f32_16x16x32_bf16 v[104:107], v[152:155], v[180:183], v[104:107]
    ds_read_b64 v[218:219], v60 offset:456
    ds_read_b128 v[220:223], v64 offset:1968
    v_mfma_f32_16x16x32_bf16 v[104:107], v[168:171], v[184:187], v[104:107]
    v_cvt_pk_bf16_f32 v163, v163, v175
    ds_read_b128 v[224:227], v61 offset:3328
    v_mfma_f32_16x16x32_bf16 v[108:111], v[152:155], v[188:191], v[108:111]
    ds_read_b128 v[228:231], v61 offset:2816
    ds_read_b128 v[232:235], v61 offset:3840
    v_mfma_f32_16x16x32_bf16 v[108:111], v[168:171], v[180:183], v[108:111]
    v_cvt_pk_bf16_f32 v200, v200, v212
    v_cvt_pk_bf16_f32 v201, v201, v213
    v_mfma_f32_16x16x32_bf16 v[104:107], v[160:163], v[192:195], v[104:107]
    v_cvt_pk_bf16_f32 v202, v202, v214
    s_waitcnt lgkmcnt(3)
    v_mfma_f32_16x16x32_bf16 v[96:99], v[196:199], v[204:207], v[96:99]
    v_cvt_pk_bf16_f32 v203, v203, v215
    ds_read_b64 v[236:237], v62 offset:1312
    v_mfma_f32_16x16x32_bf16 v[100:103], v[196:199], v[208:211], v[100:103]
    ds_read_b64 v[238:239], v62 offset:1320
    ds_read_b64 v[240:241], v60 offset:1152
    v_mfma_f32_16x16x32_bf16 v[100:103], v[216:219], v[204:207], v[100:103]
    ds_read_b64 v[242:243], v60 offset:1160
    ds_read_b128 v[244:247], v61 offset:448
    v_mfma_f32_16x16x32_bf16 v[248:251], v[220:223], v[68:71], 0
    ds_read_b128 v[252:255], v61 offset:960
    ds_read_b128 v[128:131], v61 offset:432
    v_mfma_f32_16x16x32_bf16 v[124:127], v[220:223], v[72:75], 0
    ds_read_b64 v[136:137], v60 offset:640
    s_waitcnt lgkmcnt(8)
    v_mfma_f32_16x16x32_bf16 v[104:107], v[196:199], v[224:227], v[104:107]
    ds_read_b64 v[138:139], v60 offset:648
    ds_read_b128 v[144:147], v61 offset:3520
    v_mfma_f32_16x16x32_bf16 v[104:107], v[216:219], v[228:231], v[104:107]
    ds_read_b128 v[120:123], v61 offset:944
    v_mfma_f32_16x16x32_bf16 v[108:111], v[196:199], v[232:235], v[108:111]
    v_mfma_f32_16x16x32_bf16 v[108:111], v[216:219], v[224:227], v[108:111]
    v_cvt_pk_bf16_f32 v248, v248, v124
    s_waitcnt lgkmcnt(4)
    v_mfma_f32_16x16x32_bf16 v[104:107], v[200:203], v[236:239], v[104:107]
    v_cvt_pk_bf16_f32 v249, v249, v125
    v_cvt_pk_bf16_f32 v250, v250, v126
    v_mfma_f32_16x16x32_bf16 v[96:99], v[240:243], v[244:247], v[96:99]
    ds_read_b128 v[148:151], v61 offset:3008
    v_cvt_pk_bf16_f32 v251, v251, v127
    v_mfma_f32_16x16x32_bf16 v[100:103], v[240:243], v[252:255], v[100:103]
    ds_read_b128 v[132:135], v61 offset:4032
    ds_read_b128 v[140:143], v61 offset:1456
    v_mfma_f32_16x16x32_bf16 v[164:167], v[128:131], v[76:79], 0
    ds_read_b128 v[156:159], v61 offset:1472
    v_mfma_f32_16x16x32_bf16 v[176:179], v[244:247], v[80:83], 0
    ds_read_b64 v[184:185], v60 offset:128
    s_waitcnt lgkmcnt(4)
    v_mfma_f32_16x16x32_bf16 v[100:103], v[136:139], v[244:247], v[100:103]
    ds_read_b64 v[186:187], v60 offset:136
    ds_read_b128 v[172:175], v61 offset:2496
    v_mfma_f32_16x16x32_bf16 v[104:107], v[240:243], v[144:147], v[104:107]
    ds_read_b128 v[152:155], v61 offset:1968
    ds_read_b128 v[188:191], v61 offset:1984
    v_mfma_f32_16x16x32_bf16 v[168:171], v[120:123], v[76:79], 0
    v_mfma_f32_16x16x32_bf16 v[180:183], v[252:255], v[80:83], 0
    v_cvt_pk_bf16_f32 v164, v164, v176
    v_cvt_pk_bf16_f32 v165, v165, v177
    v_mfma_f32_16x16x32_bf16 v[104:107], v[136:139], v[148:151], v[104:107]
    v_cvt_pk_bf16_f32 v166, v166, v178
    s_waitcnt lgkmcnt(3)
    v_mfma_f32_16x16x32_bf16 v[108:111], v[240:243], v[132:135], v[108:111]
    ds_read_b64 v[160:161], v60 offset:0
    ds_read_b64 v[162:163], v60 offset:8
    v_mfma_f32_16x16x32_bf16 v[212:215], v[140:143], v[76:79], 0
    v_cvt_pk_bf16_f32 v167, v167, v179
    ds_read_b64 v[208:209], v62 offset:1376
    v_mfma_f32_16x16x32_bf16 v[204:207], v[156:159], v[80:83], 0
    ds_read_b64 v[210:211], v62 offset:1384
    v_cvt_pk_bf16_f32 v168, v168, v180
    v_mfma_f32_16x16x32_bf16 v[108:111], v[136:139], v[144:147], v[108:111]
    v_cvt_pk_bf16_f32 v169, v169, v181
    s_waitcnt lgkmcnt(2)
    v_mfma_f32_16x16x32_bf16 v[104:107], v[184:187], v[172:175], v[104:107]
    ds_read_b64 v[220:221], v60 offset:896
    ds_read_b64 v[222:223], v60 offset:904
    v_mfma_f32_16x16x32_bf16 v[228:231], v[152:155], v[76:79], 0
    ds_read_b128 v[196:199], v61 offset:192
    ds_read_b128 v[232:235], v61 offset:704
    v_mfma_f32_16x16x32_bf16 v[216:219], v[188:191], v[80:83], 0
    ds_read_b64 v[224:225], v60 offset:384
    ds_read_b64 v[226:227], v60 offset:392
    v_mfma_f32_16x16x32_bf16 v[108:111], v[184:187], v[148:151], v[108:111]
    ds_read_b128 v[200:203], v64 offset:2224
    v_cvt_pk_bf16_f32 v170, v170, v182
    v_mfma_f32_16x16x32_bf16 v[104:107], v[160:163], v[156:159], v[104:107]
    v_cvt_pk_bf16_f32 v171, v171, v183
    v_cvt_pk_bf16_f32 v212, v212, v204
    v_mfma_f32_16x16x32_bf16 v[108:111], v[160:163], v[188:191], v[108:111]
    ds_read_b128 v[124:127], v61 offset:3264
    s_waitcnt lgkmcnt(2)
    v_mfma_f32_16x16x32_bf16 v[104:107], v[248:251], v[208:211], v[104:107]
    ds_read_b128 v[128:131], v61 offset:2752
    v_cvt_pk_bf16_f32 v213, v213, v205
    v_mfma_f32_16x16x32_bf16 v[108:111], v[248:251], v[192:195], v[108:111]
    ds_read_b128 v[244:247], v61 offset:3776
    v_cvt_pk_bf16_f32 v214, v214, v206
    v_mfma_f32_16x16x32_bf16 v[96:99], v[220:223], v[196:199], v[96:99]
    v_cvt_pk_bf16_f32 v215, v215, v207
    v_cvt_pk_bf16_f32 v228, v228, v216
    v_mfma_f32_16x16x32_bf16 v[100:103], v[220:223], v[232:235], v[100:103]
    ds_read_b64 v[120:121], v63 offset:1824
    ds_read_b64 v[122:123], v63 offset:1832
    v_mfma_f32_16x16x32_bf16 v[100:103], v[224:227], v[196:199], v[100:103]
    ds_read_b64 v[252:253], v63 offset:1760
    s_waitcnt lgkmcnt(3)
    v_mfma_f32_16x16x32_bf16 v[240:243], v[200:203], v[68:71], 0
    ds_read_b64 v[254:255], v63 offset:1768
    ds_read_b64 v[132:133], v63 offset:1888
    v_mfma_f32_16x16x32_bf16 v[140:143], v[200:203], v[72:75], 0
    ds_read_b64 v[134:135], v63 offset:1896
    v_cvt_pk_bf16_f32 v229, v229, v217
    v_mfma_f32_16x16x32_bf16 v[104:107], v[220:223], v[124:127], v[104:107]
    ds_read_b64 v[176:177], v60 offset:832
    ds_read_b64 v[178:179], v60 offset:840
    v_mfma_f32_16x16x32_bf16 v[104:107], v[224:227], v[128:131], v[104:107]
    s_barrier
    ds_read_b128 v[136:139], v61 offset:128
    v_mfma_f32_16x16x32_bf16 v[108:111], v[220:223], v[244:247], v[108:111]
    ds_read_b128 v[144:147], v61 offset:640
    ds_read_b64 v[172:173], v60 offset:320
    v_mfma_f32_16x16x32_bf16 v[108:111], v[224:227], v[124:127], v[108:111]
    ds_read_b64 v[174:175], v60 offset:328
    s_waitcnt lgkmcnt(4)
    v_mfma_f32_16x16x32_bf16 v[104:107], v[164:167], v[120:123], v[104:107]
    ds_read_b128 v[152:155], v64 offset:2480
    v_cvt_pk_bf16_f32 v230, v230, v218
    v_mfma_f32_16x16x32_bf16 v[108:111], v[164:167], v[252:255], v[108:111]
    ds_read_b128 v[184:187], v61 offset:3200
    v_cvt_pk_bf16_f32 v231, v231, v219
    v_mfma_f32_16x16x32_bf16 v[104:107], v[168:171], v[132:135], v[104:107]
    ds_read_b128 v[148:151], v61 offset:2688
    v_cvt_pk_bf16_f32 v240, v240, v140
    v_mfma_f32_16x16x32_bf16 v[108:111], v[168:171], v[120:123], v[108:111]
    ds_read_b128 v[156:159], v61 offset:3712
    s_waitcnt lgkmcnt(3)
    v_mfma_f32_16x16x32_bf16 v[96:99], v[176:179], v[136:139], v[96:99]
    v_cvt_pk_bf16_f32 v241, v241, v141
    v_cvt_pk_bf16_f32 v242, v242, v142
    v_mfma_f32_16x16x32_bf16 v[100:103], v[176:179], v[144:147], v[100:103]
    ds_read_b64 v[180:181], v63 offset:1952
    ds_read_b64 v[182:183], v63 offset:1960
    v_mfma_f32_16x16x32_bf16 v[100:103], v[172:175], v[136:139], v[100:103]
    v_cvt_pk_bf16_f32 v243, v243, v143
    ds_read_b64 v[160:161], v60 offset:768
    v_mfma_f32_16x16x32_bf16 v[188:191], v[152:155], v[68:71], 0
    ds_read_b64 v[162:163], v60 offset:776
    ds_read_b128 v[248:251], v61 offset:64
    v_mfma_f32_16x16x32_bf16 v[192:195], v[152:155], v[72:75], 0
    ds_read_b128 v[204:207], v61 offset:576
    s_waitcnt lgkmcnt(4)
    v_mfma_f32_16x16x32_bf16 v[104:107], v[176:179], v[184:187], v[104:107]
    ds_read_b128 v[232:235], v64 offset:2736
    v_mfma_f32_16x16x32_bf16 v[104:107], v[172:175], v[148:151], v[104:107]
    ds_read_b64 v[196:197], v60 offset:256
    ds_read_b64 v[198:199], v60 offset:264
    v_mfma_f32_16x16x32_bf16 v[108:111], v[176:179], v[156:159], v[108:111]
    ds_read_b128 v[200:203], v61 offset:3136
    v_mfma_f32_16x16x32_bf16 v[108:111], v[172:175], v[184:187], v[108:111]
    v_cvt_pk_bf16_f32 v188, v188, v192
    v_cvt_pk_bf16_f32 v189, v189, v193
    v_mfma_f32_16x16x32_bf16 v[104:107], v[212:215], v[180:183], v[104:107]
    v_cvt_pk_bf16_f32 v190, v190, v194
    v_cvt_pk_bf16_f32 v191, v191, v195
    v_mfma_f32_16x16x32_bf16 v[108:111], v[212:215], v[132:135], v[108:111]
    ds_read_b128 v[128:131], v64 offset:3248
    ds_read_b128 v[220:223], v61 offset:2624
    v_mfma_f32_16x16x32_bf16 v[108:111], v[228:231], v[180:183], v[108:111]
    ds_read_b128 v[244:247], v61 offset:3648
    s_waitcnt lgkmcnt(4)
    v_mfma_f32_16x16x32_bf16 v[96:99], v[160:163], v[248:251], v[96:99]
    v_mfma_f32_16x16x32_bf16 v[100:103], v[160:163], v[204:207], v[100:103]
    ds_read_b64 v[224:225], v62 offset:1440
    ds_read_b64 v[226:227], v62 offset:1448
    v_mfma_f32_16x16x32_bf16 v[124:127], v[232:235], v[68:71], 0
    v_mfma_f32_16x16x32_bf16 v[164:167], v[232:235], v[72:75], 0
    ds_read_b64 v[252:253], v62 offset:1504
    ds_read_b64 v[254:255], v62 offset:1512
    v_mfma_f32_16x16x32_bf16 v[100:103], v[196:199], v[248:251], v[100:103]
    s_waitcnt lgkmcnt(4)
    v_mfma_f32_16x16x32_bf16 v[104:107], v[160:163], v[200:203], v[104:107]
    ds_read_b64 v[216:217], v60 offset:704
    ds_read_b64 v[218:219], v60 offset:712
    v_mfma_f32_16x16x32_bf16 v[168:171], v[128:131], v[68:71], 0
    ds_read_b128 v[120:123], v61 offset:0
    ds_read_b128 v[144:147], v61 offset:512
    v_mfma_f32_16x16x32_bf16 v[136:139], v[128:131], v[72:75], 0
    v_cvt_pk_bf16_f32 v124, v124, v164
    v_cvt_pk_bf16_f32 v125, v125, v165
    v_mfma_f32_16x16x32_bf16 v[104:107], v[196:199], v[220:223], v[104:107]
    v_cvt_pk_bf16_f32 v126, v126, v166
    v_cvt_pk_bf16_f32 v127, v127, v167
    v_mfma_f32_16x16x32_bf16 v[108:111], v[160:163], v[244:247], v[108:111]
    ds_read_b64 v[140:141], v60 offset:192
    ds_read_b64 v[142:143], v60 offset:200
    v_mfma_f32_16x16x32_bf16 v[108:111], v[196:199], v[200:203], v[108:111]
    ds_read_b128 v[152:155], v64 offset:2992
    s_waitcnt lgkmcnt(5)
    v_mfma_f32_16x16x32_bf16 v[104:107], v[240:243], v[224:227], v[104:107]
    v_cvt_pk_bf16_f32 v168, v168, v136
    v_cvt_pk_bf16_f32 v169, v169, v137
    v_mfma_f32_16x16x32_bf16 v[108:111], v[240:243], v[236:239], v[108:111]
    ds_read_b128 v[148:151], v61 offset:3072
    v_cvt_pk_bf16_f32 v170, v170, v138
    v_mfma_f32_16x16x32_bf16 v[104:107], v[188:191], v[252:255], v[104:107]
    ds_read_b128 v[176:179], v61 offset:2560
    v_cvt_pk_bf16_f32 v171, v171, v139
    v_mfma_f32_16x16x32_bf16 v[108:111], v[188:191], v[208:211], v[108:111]
    ds_read_b128 v[156:159], v61 offset:3584
    s_waitcnt lgkmcnt(3)
    v_mfma_f32_16x16x32_bf16 v[96:99], v[216:219], v[120:123], v[96:99]
    ds_read_b64 v[172:173], v62 offset:1568
    ds_read_b64 v[174:175], v62 offset:1576
    v_mfma_f32_16x16x32_bf16 v[100:103], v[216:219], v[144:147], v[100:103]
    v_mfma_f32_16x16x32_bf16 v[100:103], v[140:143], v[120:123], v[100:103]
    v_mfma_f32_16x16x32_bf16 v[184:187], v[152:155], v[68:71], 0
    v_mfma_f32_16x16x32_bf16 v[192:195], v[152:155], v[72:75], 0
    s_waitcnt lgkmcnt(2)
    v_mfma_f32_16x16x32_bf16 v[104:107], v[216:219], v[148:151], v[104:107]
    v_mfma_f32_16x16x32_bf16 v[104:107], v[140:143], v[176:179], v[104:107]
    v_mfma_f32_16x16x32_bf16 v[108:111], v[216:219], v[156:159], v[108:111]
    v_mfma_f32_16x16x32_bf16 v[108:111], v[140:143], v[148:151], v[108:111]
    s_nop 2
    v_cvt_pk_bf16_f32 v184, v184, v192
    s_waitcnt lgkmcnt(0)
    v_mfma_f32_16x16x32_bf16 v[104:107], v[124:127], v[172:175], v[104:107]
    v_cvt_pk_bf16_f32 v185, v185, v193
    v_cvt_pk_bf16_f32 v186, v186, v194
    v_mfma_f32_16x16x32_bf16 v[108:111], v[124:127], v[224:227], v[108:111]
    v_cvt_pk_bf16_f32 v187, v187, v195
    v_cvt_pk_bf16_f32 v112, v96, v97
    v_mfma_f32_16x16x32_bf16 v[108:111], v[168:171], v[172:175], v[108:111]
    v_cvt_pk_bf16_f32 v114, v100, v101
    v_cvt_pk_bf16_f32 v113, v98, v99
    v_mfma_f32_16x16x32_bf16 v[108:111], v[184:187], v[252:255], v[108:111]
    v_cvt_pk_bf16_f32 v115, v102, v103
    v_permlane16_swap_b32 v112, v114
    s_nop 0
    v_permlane16_swap_b32 v113, v115
    global_store_dwordx4 v65, v[112:115], s[36:37] offset:-3072 sc1
    v_cvt_pk_bf16_f32 v116, v104, v105
    s_nop 2
    v_cvt_pk_bf16_f32 v118, v108, v109
    v_cvt_pk_bf16_f32 v117, v106, v107
    v_cvt_pk_bf16_f32 v119, v110, v111
    v_permlane16_swap_b32 v116, v118
    s_nop 0
    v_permlane16_swap_b32 v117, v119
    global_store_dwordx4 v65, v[116:119], s[36:37] offset:3072 sc1
    s_branch L_cvdone
L_nonconv:
    s_cmp_lg_u32 s40, 7
    s_cbranch_scc1 L_nc0
    s_lshl_b32 s53, s38, 6
    s_add_u32 s53, s53, 4063232
    v_lshl_add_u32 v4, v1, 2, s53
    v_mov_b32 v5, s42
    s_mov_b64 exec, 0xffff
    global_store_dword v4, v5, s[36:37] sc1
    s_mov_b64 exec, -1
L_nc0:
    s_cmp_eq_u32 s44, 7
    s_cbranch_scc1 L_spare
    s_mov_b32 exec_hi, 0x00ffffff
    s_mov_b32 s101, 4
L_dma1:
    s_mov_b32 m0, s97
    s_add_u32 s97, s97, 928
    global_load_lds_dwordx4 v56, s[30:31]
    v_add_u32 v56, 896, v56
    s_sub_u32 s101, s101, 1
    s_cmp_lg_u32 s101, 0
    s_cbranch_scc1 L_dma1
    s_mov_b64 exec, -1
    s_min_u32 s53, s40, 4
    s_mul_i32 s54, s40, 3
    s_add_u32 s96, s53, s54
    s_mul_i32 s53, s61, 14
    s_mul_i32 s53, s53, 2341
    s_lshr_b32 s53, s53, 16
    s_mul_i32 s53, s53, 2176
    s_add_u32 s53, s53, s45
    s_add_u32 s53, s53, 3981312
    v_lshl_add_u32 v46, v1, 3, s53
    v_mov_b32 v32, 0
    v_mov_b32 v33, 0
    s_mov_b32 exec_hi, 0
    global_atomic_add_x2 v[184:185], v46, v[32:33], s[36:37] sc0
    s_mov_b64 exec, -1
    v_min_u32 v4, 13, v58
    v_mad_u32_u24 v4, v59, 14, v4
    v_lshlrev_b32 v34, 4, v4
    v_add_u32 v4, s96, v59
    v_lshrrev_b32 v5, 2, v4
    v_mul_u32_u24 v5, 28, v5
    v_add_u32 v4, v4, v5
    v_lshlrev_b32 v4, 12, v4
    v_lshl_add_u32 v4, v58, 2, v4
    s_lshl_b32 s53, s61, 6
    s_add_u32 s53, s53, 4311040
    v_add_u32 v35, s53, v4
    s_lshr_b32 s53, s40, 2
    s_lshl_b32 s53, s53, 6
    s_and_b32 s54, s40, 1
    s_lshl_b32 s54, s54, 5
    s_add_u32 s53, s53, s54
    s_and_b32 s54, s40, 2
    s_lshl2_add_u32 s53, s54, s53
    s_add_u32 s53, s53, 143888
    v_and_b32 v4, 4, v1
    v_add_u32 v4, v4, v1
    v_lshl_add_u32 v44, v4, 1, s53
    v_lshlrev_b32 v45, 4, v59
    v_add_u32 v45, 143888, v45
    s_lshl2_add_u32 s53, s40, 143824
    v_mov_b32 v47, s53
    v_mov_b32 v48, 143824
    s_waitcnt vmcnt(5)
    s_branch L_prep
L_spare:
    s_waitcnt vmcnt(0)
    s_branch L_prep
L_ncstage:
    s_mov_b64 exec, 0
    s_cmp_eq_u32 s40, 0
    s_cbranch_scc1 L_padD_0
    s_cmp_eq_u32 s40, 1
    s_cbranch_scc1 L_padD_1
    s_cmp_eq_u32 s40, 2
    s_cbranch_scc1 L_padD_2
L_padretD:
    s_mov_b64 exec, -1
    s_mov_b64 exec, -1
    s_and_b32 s54, s40, 2
    s_lshl_b32 s54, s54, 1
    v_and_b32 v4, 1, v59
    v_xor_b32 v4, v4, v1
    v_xor_b32 v4, s54, v4
    v_and_b32 v4, 7, v4
    v_lshrrev_b32 v5, 3, v1
    v_mul_u32_u24 v5, 3584, v5
    v_lshl_add_u32 v4, v4, 4, v5
    s_mul_i32 s53, s40, 200704
    s_lshl_b32 s54, s61, 7
    s_add_u32 s53, s53, s54
    v_add_u32 v56, s53, v4
    v_xor_b32 v96, 32, v56
    s_mul_i32 s97, s40, 7168
    s_mov_b32 s101, 7
L_dma2:
    s_mov_b32 m0, s97
    s_add_u32 s97, s97, 1024
    global_load_lds_dwordx4 v56, s[26:27]
    v_add_u32 v56, 28672, v56
    s_sub_u32 s101, s101, 1
    s_cmp_lg_u32 s101, 0
    s_cbranch_scc1 L_dma2
    v_lshrrev_b32 v6, 2, v1
    v_mul_u32_u24 v6, 896, v6
    v_lshl_add_u32 v6, v1, 3, v6
    s_lshl_b32 s53, s96, 5
    s_add_u32 s53, s53, 57344
    v_add_u32 v6, s53, v6
    v_mov_b32 v56, v96
    s_add_u32 s97, s97, 50176
    s_waitcnt vmcnt(7)
    s_barrier
    ds_read_b64_tr_b16 v[152:153], v6 offset:0
    ds_read_b64_tr_b16 v[154:155], v6 offset:14848
    ds_read_b64_tr_b16 v[156:157], v6 offset:29696
    ds_read_b64_tr_b16 v[158:159], v6 offset:44544
    ds_read_b64_tr_b16 v[160:161], v6 offset:32
    ds_read_b64_tr_b16 v[162:163], v6 offset:14880
    ds_read_b64_tr_b16 v[164:165], v6 offset:29728
    ds_read_b64_tr_b16 v[166:167], v6 offset:44576
    ds_read_b64_tr_b16 v[168:169], v6 offset:64
    ds_read_b64_tr_b16 v[170:171], v6 offset:14912
    ds_read_b64_tr_b16 v[172:173], v6 offset:29760
    ds_read_b64_tr_b16 v[174:175], v6 offset:44608
    ds_read_b64_tr_b16 v[176:177], v6 offset:96
    ds_read_b64_tr_b16 v[178:179], v6 offset:14944
    ds_read_b64_tr_b16 v[180:181], v6 offset:29792
    ds_read_b64_tr_b16 v[182:183], v6 offset:44640
    s_waitcnt lgkmcnt(0)
    s_barrier
    s_mov_b32 s101, 7
L_dma3:
    s_mov_b32 m0, s97
    s_add_u32 s97, s97, 1024
    global_load_lds_dwordx4 v56, s[28:29]
    v_add_u32 v56, 28672, v56
    s_sub_u32 s101, s101, 1
    s_cmp_lg_u32 s101, 0
    s_cbranch_scc1 L_dma3
    v_bfe_u32 v4, v1, 3, 1
    v_and_b32 v5, 2, v1
    v_and_b32 v6, 1, v59
    v_lshl_or_b32 v4, v6, 2, v4
    v_or_b32 v4, v4, v5
    v_xor_b32 v4, s40, v4
    v_mul_u32_u24 v5, 28672, v5
    v_lshl_add_u32 v4, v4, 4, v5
    v_mul_u32_u24 v5, 14336, v59
    v_bfe_u32 v6, v1, 2, 2
    v_lshl_add_u32 v5, v6, 7, v5
    v_and_b32 v6, 1, v1
    v_lshl_add_u32 v5, v6, 3, v5
    v_add_u32 v56, v4, v5
    s_waitcnt lgkmcnt(0)
    s_branch L_afterprep
L_cvdone:
    s_barrier
L_prep:
L_padC_0:
    s_cbranch_execz L_padC_2
    v_lshrrev_b32 v5, 1, v0
    v_mul_u32_u24 v5, 8192, v5
    v_lshl_add_u32 v5, v0, 6, v5
    s_lshr_b32 s53, s38, 3
    s_lshl_b32 s53, s53, 8
    s_and_b32 s54, s38, 1
    s_lshl_b32 s54, s54, 7
    s_add_u32 s53, s53, s54
    s_bfe_u32 s54, s38, 0x20001
    s_lshl4_add_u32 s53, s54, s53
    s_add_u32 s53, s53, 2097152
    v_add_u32 v49, s53, v5
    s_mov_b32 s56, 0x63800000
    v_lshlrev_b32 v36, 16, v24
    v_and_b32 v37, 0xffff0000, v24
    v_lshlrev_b32 v38, 16, v25
    v_and_b32 v39, 0xffff0000, v25
    v_lshlrev_b32 v40, 16, v26
    v_and_b32 v41, 0xffff0000, v26
    v_lshlrev_b32 v42, 16, v27
    v_and_b32 v43, 0xffff0000, v27
    v_lshlrev_b32 v60, 16, v16
    v_and_b32 v61, 0xffff0000, v16
    v_lshlrev_b32 v62, 16, v17
    v_and_b32 v63, 0xffff0000, v17
    v_lshlrev_b32 v64, 16, v18
    v_and_b32 v65, 0xffff0000, v18
    v_lshlrev_b32 v66, 16, v19
    v_and_b32 v67, 0xffff0000, v19
    v_lshlrev_b32 v84, 16, v12
    v_and_b32 v85, 0xffff0000, v12
    v_lshlrev_b32 v86, 16, v13
    v_and_b32 v87, 0xffff0000, v13
    v_lshlrev_b32 v88, 16, v14
    v_and_b32 v89, 0xffff0000, v14
    v_lshlrev_b32 v90, 16, v15
    v_and_b32 v91, 0xffff0000, v15
    v_pk_mul_f32 v[36:37], v[36:37], s[56:57] op_sel:[0,0] op_sel_hi:[1,0]
    v_pk_mul_f32 v[38:39], v[38:39], s[56:57] op_sel:[0,0] op_sel_hi:[1,0]
    v_pk_mul_f32 v[40:41], v[40:41], s[56:57] op_sel:[0,0] op_sel_hi:[1,0]
    v_pk_mul_f32 v[42:43], v[42:43], s[56:57] op_sel:[0,0] op_sel_hi:[1,0]
    v_pk_fma_f32 v[84:85], v[36:37], v[60:61], v[84:85]
    v_pk_fma_f32 v[86:87], v[38:39], v[62:63], v[86:87]
    v_pk_fma_f32 v[88:89], v[40:41], v[64:65], v[88:89]
    v_pk_fma_f32 v[90:91], v[42:43], v[66:67], v[90:91]
    v_cvt_pk_bf16_f32 v68, v84, v85
    v_cvt_pk_bf16_f32 v69, v86, v87
    v_cvt_pk_bf16_f32 v70, v88, v89
    v_cvt_pk_bf16_f32 v71, v90, v91
    v_dot2_f32_bf16 v72, v20, s46, 0
    v_dot2_f32_bf16 v92, v68, s46, 0
    v_dot2_f32_bf16 v93, v68, v68, 0
    v_dot2_f32_bf16 v94, v68, v20, 0
    v_dot2_f32_bf16 v72, v21, s46, v72
    v_dot2_f32_bf16 v92, v69, s46, v92
    v_dot2_f32_bf16 v93, v69, v69, v93
    v_dot2_f32_bf16 v94, v69, v21, v94
    v_dot2_f32_bf16 v72, v22, s46, v72
    v_dot2_f32_bf16 v92, v70, s46, v92
    v_dot2_f32_bf16 v93, v70, v70, v93
    v_dot2_f32_bf16 v94, v70, v22, v94
    v_dot2_f32_bf16 v72, v23, s46, v72
    v_dot2_f32_bf16 v92, v71, s46, v92
    v_dot2_f32_bf16 v93, v71, v71, v93
    v_dot2_f32_bf16 v94, v71, v23, v94
    v_pk_add_f32 v[60:61], v[84:85], v[84:85]
    v_pk_add_f32 v[62:63], v[86:87], v[86:87]
    v_pk_add_f32 v[64:65], v[88:89], v[88:89]
    v_pk_add_f32 v[66:67], v[90:91], v[90:91]
    v_add_f32_dpp v72, v72, v72 quad_perm:[1,0,3,2] row_mask:0xf bank_mask:0xf
    v_cvt_pk_bf16_f32 v68, v60, v61
    v_cvt_pk_bf16_f32 v69, v62, v63
    v_add_f32_dpp v72, v72, v72 quad_perm:[2,3,0,1] row_mask:0xf bank_mask:0xf
    v_cvt_pk_bf16_f32 v70, v64, v65
    v_cvt_pk_bf16_f32 v71, v66, v67
    v_add_f32_dpp v72, v72, v72 row_half_mirror row_mask:0xf bank_mask:0xf
    v_mov_b32 v8, 0
    v_mov_b32 v9, 0
    v_add_f32_dpp v72, v72, v72 row_mirror row_mask:0xf bank_mask:0xf
    v_mov_b32 v10, 0
    v_mov_b32 v11, 0
    v_add_f32_dpp v72, v72, v72 row_bcast:15 row_mask:0xa bank_mask:0xf
    v_lshlrev_b32 v53, 1, v0
    v_add_u32 v53, 135632, v53
    v_add_f32_dpp v72, v72, v72 row_bcast:31 row_mask:0xc bank_mask:0xf
    v_and_b32 v55, 0x1f0, v2
    v_add_u32 v55, 143312, v55
    v_readlane_b32 s52, v72, 63
    s_lshl_b32 s53, s40, 6
    s_add_u32 s53, s53, 143312
L_padC_p3:
    s_cbranch_execz L_padretC
    v_add_u32 v54, s53, v1
    s_lshl_b32 s53, s38, 3
    s_add_u32 s53, s53, 3981312
    v_lshrrev_b32 v57, 1, v59
    v_lshl_add_u32 v57, v57, 4, v58
    v_mul_u32_u24 v57, 2176, v57
    v_add_u32 v57, s53, v57
    v_mov_b32 v51, s42
    s_lshl_b32 s53, s38, 3
    s_sub_u32 s53, 2047, s53
    v_bfe_u32 v76, v1, 2, 3
    v_sub_u32 v76, s53, v76
    s_lshl_b32 s55, s40, 2
    s_mov_b32 s47, 0x00003f80
    s_mov_b32 s48, 0x3f800000
    s_mov_b32 s56, 0x80000000
    s_mov_b32 s57, 0xffff0000
    s_cmp_lt_u32 s41, 28
    s_cbranch_scc1 L_bc2
    s_cmp_lg_u32 s44, 7
    s_cbranch_scc1 L_ncstage
L_afterprep:
    s_cmp_eq_u32 s40, 7
    s_cbranch_scc1 L_flags
    s_mov_b64 exec, 1
L_probe:
    global_load_dword v28, v49, s[36:37] sc1
    s_add_u32 s58, s58, 1
    s_waitcnt vmcnt(0)
    v_cmp_eq_u32 vcc, -1, v28
    s_cbranch_vccz L_probe_ok
    s_cmp_lt_u32 s58, 65536
    s_cbranch_scc1 L_probe
L_probe_ok:
    s_mov_b64 exec, -1
L_bc2:
    s_cmp_eq_u32 s40, 7
    s_waitcnt vmcnt(0)
    s_barrier
    s_cbranch_scc1 L_hop2_done
    global_load_dwordx4 v[28:31], v49, s[36:37] sc1
L_padC_1:
    s_cbranch_execz L_padretC
L_hop2:
    s_waitcnt vmcnt(0)
    v_max3_u32 v4, v28, v29, v30
    v_max_u32 v4, v4, v31
    v_cmp_eq_u32 vcc, -1, v4
    s_cbranch_vccz L_hop2_ok
    s_mov_b64 exec, vcc
    global_load_dwordx4 v[28:31], v49, s[36:37] sc1
    s_add_u32 s58, s58, 1
    s_cmp_lt_u32 s58, 65536
    s_cbranch_scc1 L_hop2
    s_waitcnt vmcnt(0)
L_hop2_ok:
    s_mov_b64 exec, -1
    ds_write_b16 v53, v28 offset:0
    ds_write_b16_d16_hi v53, v28 offset:960
    ds_write_b16 v53, v29 offset:1920
    ds_write_b16_d16_hi v53, v29 offset:2880
    ds_write_b16 v53, v30 offset:3840
    ds_write_b16_d16_hi v53, v30 offset:4800
    ds_write_b16 v53, v31 offset:5760
    ds_write_b16_d16_hi v53, v31 offset:6720
L_hop2_done:
    s_mov_b32 exec_hi, 0x00ffffff
    s_waitcnt lgkmcnt(0)
    s_barrier
    ds_read_b128 v[8:11], v52
    s_mov_b64 exec, -1
    s_waitcnt lgkmcnt(0)
    v_dot2_f32_bf16 v93, v8, v8, v93
    v_dot2_f32_bf16 v93, v8, v68, v93
    v_dot2_f32_bf16 v93, v9, v9, v93
    v_dot2_f32_bf16 v93, v9, v69, v93
    v_dot2_f32_bf16 v93, v10, v10, v93
    v_dot2_f32_bf16 v93, v10, v70, v93
    v_dot2_f32_bf16 v93, v11, v11, v93
    v_dot2_f32_bf16 v93, v11, v71, v93
    v_dot2_f32_bf16 v92, v8, s46, v92
    v_dot2_f32_bf16 v92, v9, s46, v92
    v_dot2_f32_bf16 v92, v10, s46, v92
    v_dot2_f32_bf16 v92, v11, s46, v92
    v_dot2_f32_bf16 v94, v8, v20, v94
    v_dot2_f32_bf16 v94, v9, v21, v94
    v_dot2_f32_bf16 v94, v10, v22, v94
    v_dot2_f32_bf16 v94, v11, v23, v94
    v_add_f32_dpp v93, v93, v93 quad_perm:[1,0,3,2] row_mask:0xf bank_mask:0xf
    v_add_f32_dpp v92, v92, v92 quad_perm:[1,0,3,2] row_mask:0xf bank_mask:0xf
    s_nop 0
    v_add_f32_dpp v94, v94, v94 quad_perm:[1,0,3,2] row_mask:0xf bank_mask:0xf
    v_add_f32_dpp v93, v93, v93 quad_perm:[2,3,0,1] row_mask:0xf bank_mask:0xf
    v_add_f32_dpp v92, v92, v92 quad_perm:[2,3,0,1] row_mask:0xf bank_mask:0xf
    v_add_f32_dpp v94, v94, v94 quad_perm:[2,3,0,1] row_mask:0xf bank_mask:0xf
    v_add_f32_dpp v93, v93, v93 row_half_mirror row_mask:0xf bank_mask:0xf
    v_add_f32_dpp v92, v92, v92 row_half_mirror row_mask:0xf bank_mask:0xf
    v_add_f32_dpp v94, v94, v94 row_half_mirror row_mask:0xf bank_mask:0xf
    v_add_f32_dpp v93, v93, v93 row_mirror row_mask:0xf bank_mask:0xf
    v_add_f32_dpp v92, v92, v92 row_mirror row_mask:0xf bank_mask:0xf
    v_add_f32_dpp v94, v94, v94 row_mirror row_mask:0xf bank_mask:0xf
    s_mov_b32 exec_lo, 0x00010001
    s_mov_b32 exec_hi, 0x00010001
    ds_write_b128 v54, v[92:95]
    s_mov_b64 exec, -1
    s_waitcnt lgkmcnt(0)
    s_barrier
    ds_read_b128 v[72:75], v55
    v_dot2_f32_bf16 v84, v8, s47, v84
    v_dot2_f32_bf16 v85, v8, s48, v85
    v_dot2_f32_bf16 v86, v9, s47, v86
    v_dot2_f32_bf16 v87, v9, s48, v87
    v_dot2_f32_bf16 v88, v10, s47, v88
    v_dot2_f32_bf16 v89, v10, s48, v89
    v_dot2_f32_bf16 v90, v11, s47, v90
    v_dot2_f32_bf16 v91, v11, s48, v91
    s_waitcnt lgkmcnt(0)
    v_add_f32_dpp v72, v72, v72 quad_perm:[1,0,3,2] row_mask:0xf bank_mask:0xf
    v_add_f32_dpp v73, v73, v73 quad_perm:[1,0,3,2] row_mask:0xf bank_mask:0xf
    v_add_f32_dpp v74, v74, v74 quad_perm:[1,0,3,2] row_mask:0xf bank_mask:0xf
    v_add_f32_dpp v72, v72, v72 quad_perm:[2,3,0,1] row_mask:0xf bank_mask:0xf
    v_add_f32_dpp v73, v73, v73 quad_perm:[2,3,0,1] row_mask:0xf bank_mask:0xf
    v_add_f32_dpp v74, v74, v74 quad_perm:[2,3,0,1] row_mask:0xf bank_mask:0xf
    v_mul_f32 v72, 0xbb124925, v72
    v_mul_f32 v73, 0x3b124925, v73
    v_fma_f32 v73, -v72, v72, v73
    v_max_f32 v73, 0, v73
    v_cvt_pk_bf16_f32 v73, 0, v73
    v_add_f32 v73, 0x3727c5ac, v73
    v_cvt_pk_bf16_f32 v73, 0, v73
    v_sqrt_f32 v73, v73
    v_cvt_pk_bf16_f32 v72, 0, v72
    v_cvt_pk_bf16_f32 v73, 0, v73
    v_rcp_f32 v73, v73
    v_fma_f32 v74, v72, s52, v74
    v_mul_f32 v74, v74, v73
    v_cvt_pk_bf16_f32 v74, 0, v74
    v_ashrrev_i32 v75, 31, v74
    v_bitop3_b32 v74, v74, v75, s56 bitop3:0x1e
    v_and_or_b32 v74, v74, s57, v76
    v_mul_f32 v72, v72, v73
    v_readlane_b32 s51, v73, s55
    v_max_u32_dpp v50, v74, v74 row_half_mirror row_mask:0xf bank_mask:0xf
    v_readlane_b32 s50, v72, s55
    v_readlane_b32 s59, v74, s55
    v_max_u32_dpp v50, v50, v50 row_mirror row_mask:0xf bank_mask:0xf
    v_add_f32 v73, 1.0, v73
    s_cmp_lg_u32 s40, 0
    v_max_u32_dpp v50, v50, v50 row_bcast:15 row_mask:0xa bank_mask:0xf
    s_cbranch_scc1 L_nokey
    s_mov_b32 exec_lo, 0x3fff0000
    s_mov_b32 exec_hi, 0x0
    global_atomic_swap_x2 v57, v[50:51], s[36:37]
    s_mov_b64 exec, -1
L_nokey:
L_padC_2:
    s_cbranch_execz L_padretC
    v_readlane_b32 s54, v50, 16
    v_readlane_b32 s57, v73, s55
    s_lshl_b32 s53, s38, 12
    s_add_u32 s53, s53, 4194304
    v_add_u32 v49, s53, v2
    s_mov_b32 s56, s50
    s_mov_b32 exec_hi, 0x00ffffff
    s_cmp_eq_u32 s54, s59
    s_cbranch_scc0 L_nohn
    v_pk_fma_f32 v[60:61], v[84:85], s[50:51], s[50:51] op_sel:[0,1,0] op_sel_hi:[1,1,0]
    v_pk_fma_f32 v[62:63], v[86:87], s[50:51], s[50:51] op_sel:[0,1,0] op_sel_hi:[1,1,0]
    v_pk_fma_f32 v[64:65], v[88:89], s[50:51], s[50:51] op_sel:[0,1,0] op_sel_hi:[1,1,0]
    v_pk_fma_f32 v[66:67], v[90:91], s[50:51], s[50:51] op_sel:[0,1,0] op_sel_hi:[1,1,0]
    v_cvt_pk_bf16_f32 v24, v60, v61
    v_cvt_pk_bf16_f32 v25, v62, v63
    v_cvt_pk_bf16_f32 v26, v64, v65
    v_cvt_pk_bf16_f32 v27, v66, v67
    global_store_dwordx4 v49, v[24:27], s[36:37] sc1
L_nohn:
    v_pk_fma_f32 v[60:61], v[84:85], s[56:57], s[56:57] op_sel:[0,1,0] op_sel_hi:[1,1,0]
    v_pk_fma_f32 v[62:63], v[86:87], s[56:57], s[56:57] op_sel:[0,1,0] op_sel_hi:[1,1,0]
    v_pk_fma_f32 v[64:65], v[88:89], s[56:57], s[56:57] op_sel:[0,1,0] op_sel_hi:[1,1,0]
    v_pk_fma_f32 v[66:67], v[90:91], s[56:57], s[56:57] op_sel:[0,1,0] op_sel_hi:[1,1,0]
    v_cvt_pk_bf16_f32 v68, v60, v61
    v_cvt_pk_bf16_f32 v69, v62, v63
    v_cvt_pk_bf16_f32 v70, v64, v65
    v_cvt_pk_bf16_f32 v71, v66, v67
    s_cselect_b32 s3, 1, 0
    s_cmp_ge_u32 s41, 28
    s_cbranch_scc1 L_ffn
L_plain:
    s_waitcnt vmcnt(0)
    s_barrier
    global_store_dwordx4 v3, v[68:71], s[32:33] sc1
    s_cmp_eq_u32 s3, 0
    s_cbranch_scc1 L_end
    s_waitcnt vmcnt(0)
    global_store_dwordx4 v49, v[68:71], s[36:37] offset:1024 sc1
    s_branch L_end
L_flags:
    v_lshlrev_b32 v4, 6, v1
    v_add_u32 v4, 4067328, v4
    v_add_u32 v5, 8192, v4
L_flchk:
    global_load_dword v28, v4, s[36:37] offset:-4096 sc1
    global_load_dword v29, v4, s[36:37] sc1
    global_load_dword v30, v5, s[36:37] offset:-4096 sc1
    global_load_dword v31, v5, s[36:37] sc1
    s_add_u32 s58, s58, 1
    s_waitcnt vmcnt(0)
    v_xor_b32 v28, s42, v28
    v_xor_b32 v29, s42, v29
    v_xor_b32 v30, s42, v30
    v_xor_b32 v31, s42, v31
    v_or3_b32 v28, v28, v29, v30
    v_or_b32 v28, v28, v31
    v_cmp_ne_u32 vcc, 0, v28
    s_cbranch_vccz L_flok
    s_mov_b64 exec, vcc
    s_cmp_lt_u32 s58, 65536
    s_cbranch_scc1 L_flchk
L_flok:
    s_mov_b64 exec, -1
    s_cmp_lt_u32 s41, 28
    s_cbranch_scc1 L_cvdone
    s_branch L_bc2
L_ffn:
L_padD_0:
    s_cbranch_execz L_padretD
    s_cmp_eq_u32 s44, 7
    s_cbranch_scc1 L_plain
    s_cmp_eq_u32 s3, 0
    s_cbranch_scc1 L_k0
    global_store_dwordx4 v49, v[68:71], s[36:37] offset:1024 sc1
L_k0:
    s_mov_b64 exec, -1
    s_mov_b32 exec_hi, 0
    global_atomic_add_x2 v[60:61], v46, v[32:33], s[36:37] sc0
    s_mov_b64 exec, -1
    ds_read_b64_tr_b16 v[96:97], v56 offset:0
    ds_read_b64_tr_b16 v[98:99], v56 offset:512
    ds_read_b64_tr_b16 v[100:101], v56 offset:1024
    ds_read_b64_tr_b16 v[102:103], v56 offset:1536
    ds_read_b64_tr_b16 v[104:105], v56 offset:2048
    ds_read_b64_tr_b16 v[106:107], v56 offset:2560
    ds_read_b64_tr_b16 v[108:109], v56 offset:3072
    ds_read_b64_tr_b16 v[110:111], v56 offset:3584
    ds_read_b64_tr_b16 v[112:113], v56 offset:4096
    ds_read_b64_tr_b16 v[114:115], v56 offset:4608
    ds_read_b64_tr_b16 v[116:117], v56 offset:5120
    ds_read_b64_tr_b16 v[118:119], v56 offset:5632
    ds_read_b64_tr_b16 v[120:121], v56 offset:6144
    ds_read_b64_tr_b16 v[122:123], v56 offset:6656
    s_mov_b32 exec_hi, 0
    global_atomic_add_x2 v[62:63], v46, v[32:33], s[36:37] sc0
    s_mov_b64 exec, -1
    ds_read_b64_tr_b16 v[124:125], v56 offset:7168
    ds_read_b64_tr_b16 v[126:127], v56 offset:7680
    ds_read_b64_tr_b16 v[128:129], v56 offset:8192
    ds_read_b64_tr_b16 v[130:131], v56 offset:8704
    ds_read_b64_tr_b16 v[132:133], v56 offset:9216
    ds_read_b64_tr_b16 v[134:135], v56 offset:9728
    ds_read_b64_tr_b16 v[136:137], v56 offset:10240
    ds_read_b64_tr_b16 v[138:139], v56 offset:10752
    ds_read_b64_tr_b16 v[140:141], v56 offset:11264
    ds_read_b64_tr_b16 v[142:143], v56 offset:11776
    ds_read_b64_tr_b16 v[144:145], v56 offset:12288
    ds_read_b64_tr_b16 v[146:147], v56 offset:12800
    ds_read_b64_tr_b16 v[148:149], v56 offset:13312
    ds_read_b64_tr_b16 v[150:151], v56 offset:13824
    s_mov_b32 exec_hi, 0
L_hop3:
    global_atomic_add_x2 v[64:65], v46, v[32:33], s[36:37] sc0
    s_waitcnt vmcnt(2)
    v_cmp_ne_u32 vcc, s42, v61
    v_mov_b32 v66, v60
    s_cbranch_vccz L_hop3_red
    global_atomic_add_x2 v[60:61], v46, v[32:33], s[36:37] sc0
    s_waitcnt vmcnt(2)
    v_cmp_ne_u32 vcc, s42, v63
    v_mov_b32 v66, v62
    s_cbranch_vccz L_hop3_red
    global_atomic_add_x2 v[62:63], v46, v[32:33], s[36:37] sc0
    s_waitcnt vmcnt(2)
    v_cmp_ne_u32 vcc, s42, v65
    v_mov_b32 v66, v64
    s_cbranch_vccz L_hop3_red
    s_add_u32 s58, s58, 1
    s_cmp_lt_u32 s58, 65536
    s_cbranch_scc1 L_hop3
L_hop3_red:
    s_nop 0
    v_max_u32_dpp v66, v66, v66 quad_perm:[1,0,3,2] row_mask:0xf bank_mask:0xf
    s_nop 1
    v_max_u32_dpp v66, v66, v66 quad_perm:[2,3,0,1] row_mask:0xf bank_mask:0xf
    s_nop 1
    v_max_u32_dpp v66, v66, v66 row_half_mirror row_mask:0xf bank_mask:0xf
    s_nop 1
    v_max_u32_dpp v66, v66, v66 row_mirror row_mask:0xf bank_mask:0xf
    s_nop 1
    v_max_u32_dpp v66, v66, v66 row_bcast:15 row_mask:0xa bank_mask:0xf
    s_mov_b32 exec_lo, 0x10000
    ds_write_b32 v47, v66
    s_mov_b64 exec, -1
    s_waitcnt lgkmcnt(0)
    s_barrier
    ds_read_b128 v[36:39], v48
    ds_read_b128 v[40:43], v48 offset:16
    s_movk_i32 s54, 0x7f8
    s_waitcnt lgkmcnt(1)
    v_max3_u32 v36, v36, v37, v38
    s_waitcnt lgkmcnt(0)
    v_max3_u32 v39, v39, v40, v41
    v_max3_u32 v36, v36, v42, v43
    v_max_u32 v36, v36, v39
    v_bfi_b32 v37, v36, 0, s54
    v_lshl_add_u32 v34, v37, 9, v34
    v_add_u32 v34, 4194304, v34
L_hop3b:
    global_load_dwordx4 v[240:243], v34, s[36:37] sc1
    v_readfirstlane_b32 s59, v36
    s_add_u32 s58, s58, 1
    s_waitcnt vmcnt(0)
    v_max3_u32 v4, v240, v241, v242
    v_max_u32 v4, v4, v243
    v_cmp_eq_u32 vcc, -1, v4
    s_cbranch_vccz L_core
    s_cmp_lt_u32 s58, 65536
    s_cbranch_scc1 L_hop3b
L_core:
L_padD_1:
    s_cbranch_execz L_padretD
    v_mfma_f32_16x16x32_bf16 v[236:239], v[240:243], v[148:151], 0
    v_mfma_f32_16x16x32_bf16 v[232:235], v[240:243], v[144:147], 0
    v_mfma_f32_16x16x32_bf16 v[228:231], v[240:243], v[140:143], 0
    v_mfma_f32_16x16x32_bf16 v[224:227], v[240:243], v[136:139], 0
    v_mfma_f32_16x16x32_bf16 v[220:223], v[240:243], v[132:135], 0
    v_mfma_f32_16x16x32_bf16 v[216:219], v[240:243], v[128:131], 0
    v_mfma_f32_16x16x32_bf16 v[212:215], v[240:243], v[124:127], 0
    v_mfma_f32_16x16x32_bf16 v[208:211], v[240:243], v[120:123], 0
    v_mfma_f32_16x16x32_bf16 v[204:207], v[240:243], v[116:119], 0
    v_mfma_f32_16x16x32_bf16 v[200:203], v[240:243], v[112:115], 0
    v_add_f32 v7, v237, v232
    v_mfma_f32_16x16x32_bf16 v[196:199], v[240:243], v[108:111], 0
    v_add_f32 v6, v231, v226
    v_mfma_f32_16x16x32_bf16 v[192:195], v[240:243], v[104:107], 0
    v_permlane16_swap_b32 v7, v11
    v_add_f32 v10, v221, v216
    v_mfma_f32_16x16x32_bf16 v[188:191], v[240:243], v[100:103], 0
    v_add_f32 v6, v6, v11
    v_add_f32 v6, v6, v10
    v_mfma_f32_16x16x32_bf16 v[184:187], v[240:243], v[96:99], 0
    v_add_f32 v5, v215, v210
    v_permlane32_swap_b32 v6, v10
    v_add_f32 v9, v205, v200
    v_add_f32 v5, v5, v9
    v_add_f32 v4, v199, v10
    v_add_f32 v4, v4, v194
    v_permlane16_swap_b32 v5, v9
    v_add_f32 v4, v4, v189
    v_add_f32 v4, v4, v9
    v_add_f32 v4, v4, v184
    v_mul_f32 v5, 0xbfb8aa3b, v4
    v_exp_f32 v5, v5
    v_mul_f32_dpp v6, v4, v4 row_shl:8 row_mask:0xf bank_mask:0xf bound_ctrl:1
    v_add_f32 v5, 1.0, v5
    v_rcp_f32 v5, v5
    s_mov_b64 exec, 0xff
    v_mul_f32 v6, v6, v5
    v_cvt_pk_bf16_f32 v6, v6, v6
    ds_write_b16 v44, v6
    s_mov_b64 exec, -1
    s_cmp_ge_u32 s40, 4
    s_waitcnt lgkmcnt(0)
    s_barrier
    ds_read_b128 v[240:243], v45
    ds_read_b128 v[244:247], v45 offset:64
    s_cbranch_scc1 L_d3
    s_waitcnt lgkmcnt(0)
    v_mfma_f32_16x16x32_bf16 v[196:199], v[240:243], v[176:179], 0
    v_mfma_f32_16x16x32_bf16 v[196:199], v[244:247], v[180:183], v[196:199]
L_d3:
    s_waitcnt lgkmcnt(0)
    v_mfma_f32_16x16x32_bf16 v[192:195], v[240:243], v[168:171], 0
    v_mfma_f32_16x16x32_bf16 v[192:195], v[244:247], v[172:175], v[192:195]
    v_mfma_f32_16x16x32_bf16 v[188:191], v[240:243], v[160:163], 0
    v_mfma_f32_16x16x32_bf16 v[188:191], v[244:247], v[164:167], v[188:191]
    v_mfma_f32_16x16x32_bf16 v[184:187], v[240:243], v[152:155], 0
    v_mfma_f32_16x16x32_bf16 v[184:187], v[244:247], v[156:159], v[184:187]
    s_cselect_b32 exec_hi, 0xffff, -1
    s_nop 2
    v_mov_b32_dpp v196, v192 quad_perm:[0,1,2,3] row_mask:0x4 bank_mask:0xf
    s_nop 1
    v_mov_b32_dpp v196, v188 quad_perm:[0,1,2,3] row_mask:0x2 bank_mask:0xf
    s_nop 1
    v_mov_b32_dpp v196, v184 quad_perm:[0,1,2,3] row_mask:0x1 bank_mask:0xf
    global_atomic_swap v35, v196, s[36:37]
    s_mov_b64 exec, -1
    s_andn2_b32 s3, 0x7ff, s59
    s_cmp_lg_u32 s40, 0
    s_cbranch_scc1 L_fout
L_padD_2:
    s_cbranch_execz L_padretD
    s_lshl_b32 s53, s38, 12
    s_add_u32 s53, s53, 4196352
    v_lshl_add_u32 v35, v1, 3, s53
    s_lshr_b32 s53, s3, 3
    s_lshl_b32 s53, s53, 12
    s_lshl_b32 s54, s61, 5
    s_add_u32 s53, s53, s54
    s_add_u32 s53, s53, 4195328
    v_and_b32 v7, 7, v1
    v_lshl_add_u32 v4, v7, 2, s53
    s_mul_i32 s53, s3, 896
    s_add_u32 s53, s53, s54
    v_lshl_add_u32 v34, v7, 2, s53
    s_ashr_i32 s54, s59, 31
    s_not_b32 s54, s54
    s_or_b32 s54, s54, 0x80000000
    s_xor_b32 s54, s59, s54
    s_and_b32 s54, s54, 0xffff0000
    v_mov_b32 v5, 0xbfb8aa3b
    v_mul_f32 v5, s54, v5
    v_exp_f32 v5, v5
    s_cmp_lg_u32 s61, 0
    v_add_f32 v5, 1.0, v5
    v_rcp_f32 v6, v5
    s_cbranch_scc1 L_hop4
    s_mov_b64 exec, 1
    global_store_dword v32, v51, s[36:37] sc1
    s_mov_b64 exec, -1
L_hop4:
    global_load_dword v104, v4, s[36:37] sc1
    v_mov_b32 v114, 0
    v_mov_b32 v115, 0
    v_mov_b32 v126, 0
    v_mov_b32 v127, 0
    global_atomic_add_x2 v[108:109], v35, v[32:33], s[36:37] sc0
    global_atomic_add_x2 v[110:111], v35, v[32:33], s[36:37] offset:512 sc0
    global_atomic_add_x2 v[112:113], v35, v[32:33], s[36:37] offset:1024 sc0
    s_mov_b32 exec_hi, 0
    global_atomic_add_x2 v[114:115], v35, v[32:33], s[36:37] offset:1536 sc0
    s_mov_b64 exec, -1
    s_sleep 4
L_hop4l:
    global_atomic_add_x2 v[120:121], v35, v[32:33], s[36:37] sc0
    global_atomic_add_x2 v[122:123], v35, v[32:33], s[36:37] offset:512 sc0
    global_atomic_add_x2 v[124:125], v35, v[32:33], s[36:37] offset:1024 sc0
    s_mov_b32 exec_hi, 0
    global_atomic_add_x2 v[126:127], v35, v[32:33], s[36:37] offset:1536 sc0
    s_mov_b64 exec, -1
    s_waitcnt vmcnt(4)
    v_max3_u32 v106, v108, v110, v112
    v_max3_u32 v107, v109, v111, v113
    v_pk_add_f32 v[96:97], v[108:109], v[110:111]
    v_max3_u32 v106, v106, v114, v115
    v_pk_add_f32 v[100:101], v[112:113], v[114:115]
    v_max_u32 v106, v106, v107
    v_cmp_eq_u32 vcc, -1, v106
    s_cbranch_vccz L_hop4_ok
    global_atomic_add_x2 v[108:109], v35, v[32:33], s[36:37] sc0
    global_atomic_add_x2 v[110:111], v35, v[32:33], s[36:37] offset:512 sc0
    global_atomic_add_x2 v[112:113], v35, v[32:33], s[36:37] offset:1024 sc0
    s_mov_b32 exec_hi, 0
    global_atomic_add_x2 v[114:115], v35, v[32:33], s[36:37] offset:1536 sc0
    s_mov_b64 exec, -1
    s_waitcnt vmcnt(4)
    v_max3_u32 v106, v120, v122, v124
    v_max3_u32 v107, v121, v123, v125
    v_pk_add_f32 v[96:97], v[120:121], v[122:123]
    v_max3_u32 v106, v106, v126, v127
    v_pk_add_f32 v[100:101], v[124:125], v[126:127]
    v_max_u32 v106, v106, v107
    v_cmp_eq_u32 vcc, -1, v106
    s_cbranch_vccz L_hop4_ok
    s_add_u32 s58, s58, 1
    s_cmp_lt_u32 s58, 65536
    s_cbranch_scc1 L_hop4l
L_hop4_ok:
    v_cmp_eq_u32 vcc, -1, v104
    s_cbranch_vccz L_hop4_ok2
    global_load_dword v104, v4, s[36:37] sc1
    s_add_u32 s58, s58, 1
    s_cmp_lt_u32 s58, 65536
    s_waitcnt vmcnt(0)
    s_cbranch_scc1 L_hop4_ok
L_hop4_ok2:
    v_pk_add_f32 v[96:97], v[96:97], v[100:101]
    v_and_b32 v105, 0xffff0000, v104
    v_lshlrev_b32 v104, 16, v104
    v_permlane32_swap_b32 v96, v97
    v_add_f32 v96, v96, v97
    s_nop 1
    v_add_f32_dpp v96, v96, v96 row_ror:8 row_mask:0xf bank_mask:0xf
    v_mov_b32 v97, v96
    s_nop 1
    v_permlane16_swap_b32 v96, v97
    v_add_f32 v96, v96, v97
    s_nop 1
    v_permlane32_swap_b32 v96, v97
    s_mov_b64 exec, 0xff
    v_pk_fma_f32 v[96:97], v[96:97], v[6:7], v[104:105] op_sel:[0,0,0] op_sel_hi:[1,0,1]
    v_cvt_pk_bf16_f32 v96, v96, v97
    global_store_dword v34, v96, s[32:33] sc1
L_fout:
    s_cmp_eq_u32 s3, s60
    s_cbranch_scc1 L_end
    s_mov_b32 exec_lo, -1
    s_mov_b32 exec_hi, 0x00ffffff
    global_store_dwordx4 v3, v[68:71], s[32:33] sc1
L_end:
L_exit0:
    s_endpgm
.p2align 7
.type L_table,@object
L_table:
.short 8448, 14684, 12604, 16640, 14812, 18848, 1376, 0
.short 12604, 12604, 12604, 12732, 14808, 18848, 1380, 0
.short 12604, 10524, 8444, 12728, 14804, 18848, 1384, 0
.short 8444, 8444, 8444, 12724, 14800, 18848, 1388, 0
.short 8444, 14680, 12600, 12720, 14796, 18848, 1392, 0
.short 12600, 12600, 12600, 12716, 14792, 18848, 1396, 0
.short 12600, 10520, 8440, 12712, 14788, 18848, 1400, 0
.short 8440, 8440, 8440, 12708, 14784, 18848, 1404, 0
.short 8440, 14676, 12596, 12704, 14780, 18848, 1408, 0
.short 12596, 12596, 12596, 12700, 14776, 18848, 1412, 0
.short 12596, 10516, 8436, 12696, 14772, 18848, 1416, 0
.short 8436, 8436, 8436, 12692, 14768, 18848, 1420, 0
.short 8436, 14672, 12592, 12688, 14764, 18848, 1424, 0
.short 12592, 12592, 12592, 12684, 14760, 18848, 1428, 0
.short 12592, 10512, 8432, 12680, 14756, 18848, 1432, 0
.short 8432, 8432, 8432, 12676, 14752, 18848, 1436, 0
.short 8432, 14668, 12588, 12672, 14748, 18848, 1440, 0
.short 12588, 12588, 12588, 12668, 14744, 18848, 1444, 0
.short 12588, 10508, 8428, 12664, 14740, 18848, 1448, 0
.short 8428, 8428, 8428, 12660, 14736, 18848, 1452, 0
.short 8428, 14664, 12584, 12656, 14732, 18848, 1456, 0
.short 12584, 12584, 12584, 12652, 14728, 18848, 1460, 0
.short 12584, 10504, 8424, 12648, 14724, 18848, 1464, 0
.short 8424, 8424, 8424, 12644, 14720, 18848, 1468, 0
.short 8424, 14660, 12580, 12640, 14716, 18848, 1472, 0
.short 12580, 12580, 12580, 12636, 14712, 18848, 1476, 0
.short 12580, 10500, 8420, 12632, 14708, 18848, 1480, 0
.short 8420, 8420, 8420, 12628, 14704, 18848, 1484, 0
.short 8420, 14656, 12576, 12624, 14700, 18848, 1488, 0
.short 12576, 12576, 12576, 12620, 14696, 18848, 1492, 0
.short 12576, 10496, 8416, 12616, 14692, 18848, 1496, 0
.short 8416, 8416, 8416, 12612, 14688, 18848, 1500, 0
.short 8416, 14652, 12572, 12608, 10652, 18848, 1504, 0
.short 12572, 12572, 12572, 8572, 10648, 18848, 1508, 0
.short 12572, 10492, 8412, 8568, 10644, 18848, 1512, 0
.short 8412, 8412, 8412, 8564, 10640, 18848, 1516, 0
.short 8412, 14648, 12568, 8560, 10636, 18848, 1520, 0
.short 12568, 12568, 12568, 8556, 10632, 18848, 1524, 0
.short 12568, 10488, 8408, 8552, 10628, 18848, 1528, 0
.short 8408, 8408, 8408, 8548, 10624, 18848, 1532, 0
.short 8408, 14644, 12564, 8544, 10620, 18848, 1536, 0
.short 12564, 12564, 12564, 8540, 10616, 18848, 1540, 0
.short 12564, 10484, 8404, 8536, 10612, 18848, 1544, 0
.short 8404, 8404, 8404, 8532, 10608, 18848, 1548, 0
.short 8404, 14640, 12560, 8528, 10604, 18848, 1552, 0
.short 12560, 12560, 12560, 8524, 10600, 18848, 1556, 0
.short 12560, 10480, 8400, 8520, 10596, 18848, 1560, 0
.short 8400, 8400, 8400, 8516, 10592, 18848, 1564, 0
.short 8400, 14636, 12556, 8512, 10588, 18848, 1568, 0
.short 12556, 12556, 12556, 8508, 10584, 18848, 1572, 0
.short 12556, 10476, 8396, 8504, 10580, 18848, 1576, 0
.short 8396, 8396, 8396, 8500, 10576, 18848, 1580, 0
.short 8396, 14632, 12552, 8496, 10572, 18848, 1584, 0
.short 12552, 12552, 12552, 8492, 10568, 18848, 1588, 0
.short 12552, 10472, 8392, 8488, 10564, 18848, 1592, 0
.short 8392, 8392, 8392, 8484, 10560, 18848, 1596, 0
.short 8392, 14628, 12548, 8480, 10556, 18848, 1600, 0
.short 12548, 12548, 12548, 8476, 10552, 18848, 1604, 0
.short 12548, 10468, 8388, 8472, 10548, 18848, 1608, 0
.short 8388, 8388, 8388, 8468, 10544, 18848, 1612, 0
.short 8388, 14624, 12544, 8464, 10540, 18848, 1616, 0
.short 12544, 12544, 12544, 8460, 10536, 18848, 1620, 0
.short 12544, 10464, 8384, 8456, 10532, 18848, 1624, 0
.short 8384, 8384, 8384, 8452, 10528, 18848, 1628, 0
.short 8384, 14620, 12540, 16768, 23004, 18848, 1760, 0
.short 12540, 12540, 12540, 23000, 22996, 18848, 1764, 0
.short 12540, 10460, 8380, 22992, 22988, 18848, 1768, 0
.short 8380, 8380, 8380, 22984, 22980, 18848, 1772, 0
.short 8380, 14616, 12536, 22976, 22972, 18848, 1776, 0
.short 12536, 12536, 12536, 22968, 22964, 18848, 1780, 0
.short 12536, 10456, 8376, 22960, 22956, 18848, 1784, 0
.short 8376, 8376, 8376, 22952, 22948, 18848, 1788, 0
.short 8376, 14612, 12532, 22944, 22940, 18848, 1792, 0
.short 12532, 12532, 12532, 22936, 22932, 18848, 1796, 0
.short 12532, 10452, 8372, 22928, 22924, 18848, 1800, 0
.short 8372, 8372, 8372, 22920, 22916, 18848, 1804, 0
.short 8372, 14608, 12528, 22912, 22908, 18848, 1808, 0
.short 12528, 12528, 12528, 22904, 22900, 18848, 1812, 0
.short 12528, 10448, 8368, 22896, 22892, 18848, 1816, 0
.short 8368, 8368, 8368, 22888, 22884, 18848, 1820, 0
.short 8368, 14604, 12524, 22880, 20924, 18848, 1824, 0
.short 12524, 12524, 12524, 20920, 20916, 18848, 1828, 0
.short 12524, 10444, 8364, 20912, 20908, 18848, 1832, 0
.short 8364, 8364, 8364, 20904, 20900, 18848, 1836, 0
.short 8364, 14600, 12520, 20896, 20892, 18848, 1840, 0
.short 12520, 12520, 12520, 20888, 20884, 18848, 1844, 0
.short 12520, 10440, 8360, 20880, 20876, 18848, 1848, 0
.short 8360, 8360, 8360, 20872, 20868, 18848, 1852, 0
.short 8360, 14596, 12516, 20864, 20860, 18848, 1856, 0
.short 12516, 12516, 12516, 20856, 20852, 18848, 1860, 0
.short 12516, 10436, 8356, 20848, 20844, 18848, 1864, 0
.short 8356, 8356, 8356, 20840, 20836, 18848, 1868, 0
.short 8356, 14592, 12512, 20832, 20828, 18848, 1872, 0
.short 12512, 12512, 12512, 20824, 20820, 18848, 1876, 0
.short 12512, 10432, 8352, 20816, 20812, 18848, 1880, 0
.short 8352, 8352, 8352, 20808, 20804, 18848, 1884, 0
.short 8352, 14588, 12508, 20800, 18844, 18848, 1888, 0
.short 12508, 12508, 12508, 18840, 18836, 18848, 1892, 0
.short 12508, 10428, 8348, 18832, 18828, 18848, 1896, 0
.short 8348, 8348, 8348, 18824, 18820, 18848, 1900, 0
.short 8348, 14584, 12504, 18816, 18812, 18848, 1904, 0
.short 12504, 12504, 12504, 18808, 18804, 18848, 1908, 0
.short 12504, 10424, 8344, 18800, 18796, 18848, 1912, 0
.short 8344, 8344, 8344, 18792, 18788, 18848, 1916, 0
.short 8344, 14580, 12500, 18784, 18780, 18848, 1920, 0
.short 12500, 12500, 12500, 18776, 18772, 18848, 1924, 0
.short 12500, 10420, 8340, 18768, 18764, 18848, 1928, 0
.short 8340, 8340, 8340, 18760, 18756, 18848, 1932, 0
.short 8340, 14576, 12496, 18752, 18748, 18848, 1936, 0
.short 12496, 12496, 12496, 18744, 18740, 18848, 1940, 0
.short 12496, 10416, 8336, 18736, 18732, 18848, 1944, 0
.short 8336, 8336, 8336, 18728, 18724, 18848, 1948, 0
.short 8336, 14572, 12492, 18720, 16764, 18848, 1952, 0
.short 12492, 12492, 12492, 16760, 16756, 18848, 1956, 0
.short 12492, 10412, 8332, 16752, 16748, 18848, 1960, 0
.short 8332, 8332, 8332, 16744, 16740, 18848, 1964, 0
.short 8332, 14568, 12488, 16736, 16732, 18848, 1968, 0
.short 12488, 12488, 12488, 16728, 16724, 18848, 1972, 0
.short 12488, 10408, 8328, 16720, 16716, 18848, 1976, 0
.short 8328, 8328, 8328, 16712, 16708, 18848, 1980, 0
.short 8328, 14564, 12484, 16704, 16700, 18848, 1984, 0
.short 12484, 12484, 12484, 16696, 16692, 18848, 1988, 0
.short 12484, 10404, 8324, 16688, 16684, 18848, 1992, 0
.short 8324, 8324, 8324, 16680, 16676, 18848, 1996, 0
.short 8324, 14560, 12480, 16672, 16668, 18848, 2000, 0
.short 12480, 12480, 12480, 16664, 16660, 18848, 2004, 0
.short 12480, 10400, 8320, 16656, 16652, 18848, 2008, 0
.short 8320, 8320, 6492, 16648, 16644, 18848, 2012, 0
.short 6492, 6364, 4412, 18848, 8448, 8448, 184, 0
.short 4412, 4284, 2332, 8448, 8448, 8448, 188, 0
.short 2332, 2204, 252, 18848, 16640, 16640, 52, 0
.short 252, 124, 6488, 16640, 18848, 18848, 56, 0
.short 6488, 6360, 4408, 18848, 18848, 18848, 80, 0
.short 4408, 4280, 2328, 18848, 18848, 18848, 80, 0
.short 2328, 2200, 248, 18848, 18848, 18848, 80, 0
.short 248, 120, 6484, 18848, 18848, 18848, 80, 0
.short 6484, 6356, 4404, 18848, 18848, 18848, 80, 0
.short 4404, 4276, 2324, 18848, 18848, 18848, 80, 0
.short 2324, 2196, 244, 18848, 18848, 18848, 80, 0
.short 244, 116, 6480, 18848, 18848, 18848, 80, 0
.short 6480, 6352, 4400, 18848, 18848, 18848, 80, 0
.short 4400, 4272, 2320, 18848, 18848, 18848, 80, 0
.short 2320, 2192, 240, 18848, 18848, 18848, 80, 0
.short 240, 112, 6476, 18848, 18848, 18848, 80, 0
.short 6476, 6348, 4396, 18848, 18848, 18848, 80, 0
.short 4396, 4268, 2316, 18848, 18848, 18848, 80, 0
.short 2316, 2188, 236, 18848, 18848, 18848, 80, 0
.short 236, 108, 6472, 18848, 18848, 18848, 80, 0
.short 6472, 6344, 4392, 18848, 18848, 18848, 80, 0
.short 4392, 4264, 2312, 18848, 18848, 18848, 80, 0
.short 2312, 2184, 232, 18848, 18848, 18848, 80, 0
.short 232, 104, 6468, 18848, 18848, 18848, 80, 0
.short 6468, 6340, 4388, 18848, 18848, 18848, 80, 0
.short 4388, 4260, 2308, 18848, 18848, 18848, 80, 0
.short 2308, 2180, 228, 18848, 18848, 18848, 80, 0
.short 228, 100, 6464, 18848, 18848, 18848, 80, 0
.short 6464, 6336, 4384, 18848, 18848, 18848, 80, 0
.short 4384, 4256, 2304, 18848, 18848, 18848, 80, 0
.short 2304, 2176, 224, 18848, 18848, 18848, 80, 0
.short 224, 96, 6460, 18848, 18848, 18848, 80, 0
.short 6460, 6332, 4380, 18848, 18848, 18848, 80, 0
.short 4380, 4252, 2300, 18848, 18848, 18848, 80, 0
.short 2300, 2172, 220, 18848, 18848, 18848, 80, 0
.short 220, 92, 6456, 18848, 18848, 18848, 80, 0
.short 6456, 6328, 4376, 18848, 18848, 18848, 80, 0
.short 4376, 4248, 2296, 18848, 18848, 18848, 80, 0
.short 2296, 2168, 216, 18848, 18848, 18848, 80, 0
.short 216, 88, 6452, 18848, 18848, 18848, 80, 0
.short 6452, 6324, 4372, 18848, 18848, 18848, 80, 0
.short 4372, 4244, 2292, 18848, 18848, 18848, 80, 0
.short 2292, 2164, 212, 18848, 18848, 18848, 80, 0
.short 212, 84, 6448, 18848, 18848, 18848, 80, 0
.short 6448, 6320, 4368, 18848, 18848, 18848, 80, 0
.short 4368, 4240, 2288, 18848, 18848, 18848, 80, 0
.short 2288, 2160, 208, 18848, 18848, 18848, 80, 0
.short 208, 80, 6444, 18848, 18848, 18848, 80, 0
.short 6444, 6316, 4364, 18848, 18848, 18848, 80, 0
.short 4364, 4236, 2284, 18848, 18848, 18848, 80, 0
.short 2284, 2156, 204, 18848, 18848, 18848, 80, 0
.short 204, 76, 6440, 18848, 18848, 18848, 80, 0
.short 6440, 6312, 4360, 18848, 18848, 18848, 80, 0
.short 4360, 4232, 2280, 18848, 18848, 18848, 80, 0
.short 2280, 2152, 200, 18848, 18848, 18848, 80, 0
.short 200, 72, 6436, 18848, 18848, 18848, 80, 0
.short 6436, 6308, 4356, 18848, 18848, 18848, 80, 0
.short 4356, 4228, 2276, 18848, 18848, 18848, 80, 0
.short 2276, 2148, 196, 18848, 18848, 18848, 80, 0
.short 196, 68, 6432, 18848, 18848, 18848, 80, 0
.short 6432, 6304, 4352, 18848, 18848, 18848, 80, 0
.short 4352, 4224, 2272, 18848, 18848, 18848, 80, 0
.short 2272, 2144, 192, 18848, 18848, 18848, 80, 0
.short 192, 64, 6428, 18848, 18848, 18848, 80, 0
.short 6428, 6300, 4348, 18848, 18848, 18848, 80, 0
.short 4348, 4220, 2268, 18848, 18848, 18848, 80, 0
.short 2268, 2140, 188, 18848, 18848, 18848, 80, 0
.short 188, 60, 6424, 18848, 18848, 18848, 80, 0
.short 6424, 6296, 4344, 18848, 18848, 18848, 80, 0
.short 4344, 4216, 2264, 18848, 18848, 18848, 80, 0
.short 2264, 2136, 184, 18848, 18848, 18848, 80, 0
.short 184, 56, 6420, 18848, 18848, 18848, 80, 0
.short 6420, 6292, 4340, 18848, 18848, 18848, 80, 0
.short 4340, 4212, 2260, 18848, 18848, 18848, 80, 0
.short 2260, 2132, 180, 18848, 18848, 18848, 80, 0
.short 180, 52, 6416, 18848, 18848, 18848, 80, 0
.short 6416, 6288, 4336, 18848, 18848, 18848, 80, 0
.short 4336, 4208, 2256, 18848, 18848, 18848, 80, 0
.short 2256, 2128, 176, 18848, 18848, 18848, 80, 0
.short 176, 48, 6412, 18848, 18848, 18848, 80, 0
.short 6412, 6284, 4332, 18848, 18848, 18848, 80, 0
.short 4332, 4204, 2252, 18848, 18848, 18848, 80, 0
.short 2252, 2124, 172, 18848, 18848, 18848, 80, 0
.short 172, 44, 6408, 18848, 18848, 18848, 80, 0
.short 6408, 6280, 4328, 18848, 18848, 18848, 80, 0
.short 4328, 4200, 2248, 18848, 18848, 18848, 80, 0
.short 2248, 2120, 168, 18848, 18848, 18848, 80, 0
.short 168, 40, 6404, 18848, 18848, 18848, 80, 0
.short 6404, 6276, 4324, 18848, 18848, 18848, 80, 0
.short 4324, 4196, 2244, 18848, 18848, 18848, 80, 0
.short 2244, 2116, 164, 18848, 18848, 18848, 80, 0
.short 164, 36, 6400, 18848, 18848, 18848, 80, 0
.short 6400, 6272, 4320, 18848, 18848, 18848, 80, 0
.short 4320, 4192, 2240, 18848, 18848, 18848, 80, 0
.short 2240, 2112, 160, 18848, 18848, 18848, 80, 0
.short 160, 32, 6396, 18848, 18848, 18848, 80, 0
.short 6396, 6268, 4316, 18848, 18848, 18848, 80, 0
.short 4316, 4188, 2236, 18848, 18848, 18848, 80, 0
.short 2236, 2108, 156, 18848, 18848, 18848, 80, 0
.short 156, 28, 6392, 18848, 18848, 18848, 80, 0
.short 6392, 6264, 4312, 18848, 18848, 18848, 80, 0
.short 4312, 4184, 2232, 18848, 18848, 18848, 80, 0
.short 2232, 2104, 152, 18848, 18848, 18848, 80, 0
.short 152, 24, 6388, 18848, 18848, 18848, 80, 0
.short 6388, 6260, 4308, 18848, 18848, 18848, 80, 0
.short 4308, 4180, 2228, 18848, 18848, 18848, 80, 0
.short 2228, 2100, 148, 18848, 18848, 18848, 80, 0
.short 148, 20, 6384, 18848, 18848, 18848, 80, 0
.short 6384, 6256, 4304, 18848, 18848, 18848, 80, 0
.short 4304, 4176, 2224, 18848, 18848, 18848, 80, 0
.short 2224, 2096, 144, 18848, 18848, 18848, 80, 0
.short 144, 16, 6380, 18848, 18848, 18848, 80, 0
.short 6380, 6252, 4300, 18848, 18848, 18848, 80, 0
.short 4300, 4172, 2220, 18848, 18848, 18848, 80, 0
.short 2220, 2092, 140, 18848, 18848, 18848, 80, 0
.short 140, 12, 6376, 18848, 18848, 18848, 80, 0
.short 6376, 6248, 4296, 18848, 18848, 18848, 80, 0
.short 4296, 4168, 2216, 18848, 18848, 18848, 80, 0
.short 2216, 2088, 136, 18848, 18848, 18848, 80, 0
.short 136, 8, 6372, 18848, 18848, 18848, 80, 0
.short 6372, 6244, 4292, 18848, 18848, 18848, 80, 0
.short 4292, 4164, 2212, 18848, 18848, 18848, 80, 0
.short 2212, 2084, 132, 18848, 18848, 18848, 80, 0
.short 132, 4, 6368, 18848, 18848, 18848, 80, 0
.short 6368, 6240, 4288, 18848, 18848, 18848, 80, 0
.short 4288, 4160, 2208, 18848, 18848, 18848, 80, 0
.short 2208, 2080, 128, 18848, 18848, 18848, 80, 0
.short 128, 0, 18848, 18848, 18848, 18848, 80, 0
.short 0, 0, 0, 0, 0, 0, 0x3f80, 0x3f80
.short 0, 0, 0, 0, 0, 0, 0, 0x3f80
.short 0, 0, 0, 0, 0, 0, 0, 0
.short 0, 0, 0, 0, 0, 0, 0, 0
.short 0, 0, 0, 0, 0, 0, 0, 0
.short 0, 0, 0, 0, 0, 0, 0, 0
.short 0, 0, 0, 0, 0, 0, 0, 0
.short 0, 0, 0, 0, 0, 0, 0, 0
.short 0, 0, 0, 0, 0, 0, 0, 0
.short 0, 0, 0, 0, 0, 0, 0, 0
.short 0, 0, 0, 0, 0, 0, 0, 0
.short 0, 0, 0, 0, 0, 0, 0, 0
.short 0, 0, 0, 0, 0, 0, 0, 0
.short 0, 0, 0, 0, 0, 0, 0, 0
.short 0, 0, 0, 0, 0, 0, 0, 0
.short 0, 0, 0, 0, 0, 0, 0, 0
.short 0x3f80, 0x3f80, 0x3f80, 0, 0, 0, 0, 0
.short 0x3f80, 0x3f80, 0x3f80, 0x3f80, 0, 0, 0, 0
.short 0x3f80, 0x3f80, 0x3f80, 0x3f80, 0x3f80, 0, 0, 0
.short 0, 0x3f80, 0x3f80, 0x3f80, 0x3f80, 0x3f80, 0, 0
.short 0, 0, 0x3f80, 0x3f80, 0x3f80, 0x3f80, 0x3f80, 0
.short 0, 0, 0, 0x3f80, 0x3f80, 0x3f80, 0x3f80, 0x3f80
.short 0, 0, 0, 0, 0x3f80, 0x3f80, 0x3f80, 0x3f80
.short 0, 0, 0, 0, 0, 0x3f80, 0x3f80, 0x3f80
.short 0, 0, 0, 0, 0, 0, 0x3f80, 0x3f80
.short 0, 0, 0, 0, 0, 0, 0, 0x3f80
.short 0, 0, 0, 0, 0, 0, 0, 0
.short 0, 0, 0, 0, 0, 0, 0, 0
.short 0, 0, 0, 0, 0, 0, 0, 0
.short 0, 0, 0, 0, 0, 0, 0, 0
.short 0, 0, 0, 0, 0, 0, 0, 0
.short 0, 0, 0, 0, 0, 0, 0, 0
.short 0, 0, 0, 0, 0, 0, 0, 0
.short 0, 0, 0, 0, 0, 0, 0, 0
.short 0, 0, 0, 0, 0, 0, 0, 0
.short 0, 0, 0, 0, 0, 0, 0, 0
.short 0, 0, 0, 0, 0, 0, 0, 0
.short 0, 0, 0, 0, 0, 0, 0, 0
.short 0x3f80, 0, 0, 0, 0, 0, 0, 0
.short 0x3f80, 0x3f80, 0, 0, 0, 0, 0, 0
.short 0x3f80, 0x3f80, 0x3f80, 0, 0, 0, 0, 0
.short 0x3f80, 0x3f80, 0x3f80, 0x3f80, 0, 0, 0, 0
.short 0x3f80, 0x3f80, 0x3f80, 0x3f80, 0x3f80, 0, 0, 0
.short 0, 0x3f80, 0x3f80, 0x3f80, 0x3f80, 0x3f80, 0, 0
.short 0, 0, 0x3f80, 0x3f80, 0x3f80, 0x3f80, 0x3f80, 0
.short 0, 0, 0, 0x3f80, 0x3f80, 0x3f80, 0x3f80, 0x3f80
.short 0, 0, 0, 0, 0x3f80, 0x3f80, 0x3f80, 0x3f80
.short 0, 0, 0, 0, 0, 0x3f80, 0x3f80, 0x3f80
.short 0, 0, 0, 0, 0, 0, 0, 0
.short 0, 0, 0, 0, 0, 0, 0, 0
.short 0, 0, 0, 0, 0, 0, 0, 0
.short 0, 0, 0, 0, 0, 0, 0, 0
.short 0, 0, 0, 0, 0, 0, 0, 0
.short 0, 0, 0, 0, 0, 0, 0, 0
.short 0, 0, 0, 0, 0, 0, 0, 0
.short 0, 0, 0, 0, 0, 0, 0, 0
.short 0, 0, 0, 0, 0, 0, 0, 0
.short 0, 0, 0, 0, 0, 0, 0, 0
.short 0, 0, 0, 0, 0, 0, 0, 0
.short 0, 0, 0, 0, 0, 0, 0, 0
.short 0, 0, 0, 0, 0, 0, 0, 0
.short 0, 0, 0, 0, 0, 0, 0, 0
.short 0x3f80, 0, 0, 0, 0, 0, 0, 0
.short 0x3f80, 0x3f80, 0, 0, 0, 0, 0, 0
.short 0, 0, 0, 0, 0, 0, 0, 0
.short 0, 0, 0, 0, 0, 0, 0, 0
.short 0, 0, 0, 0, 0, 0, 0, 0
.short 0, 0, 0, 0, 0, 0, 0, 0
.short 0, 0, 0, 0, 0, 0, 0, 0
.short 0, 0, 0, 0, 0, 0, 0, 0
.short 0, 0, 0, 0, 0, 0, 0, 0
.short 0, 0, 0, 0, 0, 0, 0, 0
.short 0, 0, 0, 0, 0, 0, 0, 0
.short 0, 0, 0, 0, 0, 0, 0, 0
.short 0, 0, 0, 0, 0, 0, 0, 0
.short 0, 0, 0, 0, 0, 0, 0, 0
.short 0, 0, 0, 0, 0, 0, 0, 0
.short 0, 0, 0, 0, 0, 0, 0, 0
.short 0, 0, 0, 0, 0, 0, 0, 0
.short 0, 0, 0, 0, 0, 0, 0, 0
.short 0, 0, 0, 0x3f80, 0x3f80, 0x3f80, 0, 0
.short 0, 0, 0, 0, 0x3f80, 0x3f80, 0x3f80, 0
.short 0, 0, 0, 0, 0, 0x3f80, 0x3f80, 0x3f80
.short 0, 0, 0, 0, 0, 0, 0x3f80, 0x3f80
.short 0, 0, 0, 0, 0, 0, 0, 0x3f80
.short 0, 0, 0, 0, 0, 0, 0, 0
.short 0, 0, 0, 0, 0, 0, 0, 0
.short 0, 0, 0, 0, 0, 0, 0, 0
.short 0, 0, 0, 0, 0, 0, 0, 0
.short 0, 0, 0, 0, 0, 0, 0, 0
.short 0, 0, 0, 0, 0, 0, 0, 0
.short 0, 0, 0, 0, 0, 0, 0, 0
.short 0, 0, 0, 0, 0, 0, 0, 0
.short 0, 0, 0, 0, 0, 0, 0, 0
.short 0, 0, 0, 0, 0, 0, 0, 0
.short 0, 0, 0, 0, 0, 0, 0, 0
.short 0, 0, 0, 0, 0, 0, 0, 0
.short 0, 0, 0, 0, 0, 0, 0, 0
.short 0, 0, 0, 0, 0, 0, 0, 0
.short 0x3f80, 0, 0, 0, 0, 0, 0, 0
.short 0x3f80, 0x3f80, 0, 0, 0, 0, 0, 0
.short 0x3f80, 0x3f80, 0x3f80, 0, 0, 0, 0, 0
.short 0, 0x3f80, 0x3f80, 0x3f80, 0, 0, 0, 0
.short 0, 0, 0x3f80, 0x3f80, 0x3f80, 0, 0, 0
.short 0, 0, 0, 0x3f80, 0x3f80, 0x3f80, 0, 0
.short 0, 0, 0, 0, 0x3f80, 0x3f80, 0x3f80, 0
.short 0, 0, 0, 0, 0, 0x3f80, 0x3f80, 0x3f80
.short 0, 0, 0, 0, 0, 0, 0x3f80, 0x3f80
.short 0, 0, 0, 0, 0, 0, 0, 0x3f80
.short 0, 0, 0, 0, 0, 0, 0, 0
.short 0, 0, 0, 0, 0, 0, 0, 0
.short 0, 0, 0, 0, 0, 0, 0, 0
.short 0, 0, 0, 0, 0, 0, 0, 0
.short 0, 0, 0, 0, 0, 0, 0, 0
.short 0, 0, 0, 0, 0, 0, 0, 0
.short 0, 0, 0, 0, 0, 0, 0, 0
.short 0, 0, 0, 0, 0, 0, 0, 0
.short 0, 0, 0, 0, 0, 0, 0, 0
.short 0, 0, 0, 0, 0, 0, 0, 0
.short 0, 0, 0, 0, 0, 0, 0, 0
.short 0, 0, 0, 0, 0, 0, 0, 0
.short 0, 0, 0, 0, 0, 0, 0, 0
.short 0, 0, 0, 0, 0, 0, 0, 0
.short 0x3f80, 0, 0, 0, 0, 0, 0, 0
.short 0x3f80, 0x3f80, 0, 0, 0, 0, 0, 0
.short 0x3f80, 0x3f80, 0x3f80, 0, 0, 0, 0, 0
.short 0, 0x3f80, 0x3f80, 0x3f80, 0, 0, 0, 0
.short 0, 0, 0x3f80, 0x3f80, 0x3f80, 0, 0, 0
.short 0, 0, 0, 0, 0x3f80, 0x3f80, 0x3f80, 0x3f80
.short 0, 0, 0, 0, 0, 0x3f80, 0x3f80, 0x3f80
.short 0, 0, 0, 0, 0, 0, 0x3f80, 0x3f80
.short 0, 0, 0, 0, 0, 0, 0, 0x3f80
.short 0, 0, 0, 0, 0, 0, 0, 0
.short 0, 0, 0, 0, 0, 0, 0, 0
.short 0, 0, 0, 0, 0, 0, 0, 0
.short 0, 0, 0, 0, 0, 0, 0, 0
.short 0, 0, 0, 0, 0, 0, 0, 0
.short 0, 0, 0, 0, 0, 0, 0, 0
.short 0, 0, 0, 0, 0, 0, 0, 0
.short 0, 0, 0, 0, 0, 0, 0, 0
.short 0, 0, 0, 0, 0, 0, 0, 0
.short 0, 0, 0, 0, 0, 0, 0, 0
.short 0, 0, 0, 0, 0, 0, 0, 0
.short 0, 0, 0, 0, 0, 0, 0, 0
.short 0x3f80, 0x3f80, 0x3f80, 0x3f80, 0x3f80, 0, 0, 0
.short 0x3f80, 0x3f80, 0x3f80, 0x3f80, 0x3f80, 0x3f80, 0, 0
.short 0x3f80, 0x3f80, 0x3f80, 0x3f80, 0x3f80, 0x3f80, 0x3f80, 0
.short 0x3f80, 0x3f80, 0x3f80, 0x3f80, 0x3f80, 0x3f80, 0x3f80, 0x3f80
.short 0x3f80, 0x3f80, 0x3f80, 0x3f80, 0x3f80, 0x3f80, 0x3f80, 0x3f80
.short 0, 0x3f80, 0x3f80, 0x3f80, 0x3f80, 0x3f80, 0x3f80, 0x3f80
.short 0, 0, 0x3f80, 0x3f80, 0x3f80, 0x3f80, 0x3f80, 0x3f80
.short 0, 0, 0, 0x3f80, 0x3f80, 0x3f80, 0x3f80, 0x3f80
.short 0, 0, 0, 0, 0x3f80, 0x3f80, 0x3f80, 0x3f80
.short 0, 0, 0, 0, 0, 0x3f80, 0x3f80, 0x3f80
.short 0, 0, 0, 0, 0, 0, 0x3f80, 0x3f80
.short 0, 0, 0, 0, 0, 0, 0, 0x3f80
.short 0, 0, 0, 0, 0, 0, 0, 0
.short 0, 0, 0, 0, 0, 0, 0, 0
.short 0, 0, 0, 0, 0, 0, 0, 0
.short 0, 0, 0, 0, 0, 0, 0, 0
.short 0, 0, 0, 0, 0, 0, 0, 0
.short 0, 0, 0, 0, 0, 0, 0, 0
.short 0, 0, 0, 0, 0, 0, 0, 0
.short 0, 0, 0, 0, 0, 0, 0, 0
.short 0x3f80, 0, 0, 0, 0, 0, 0, 0
.short 0x3f80, 0x3f80, 0, 0, 0, 0, 0, 0
.short 0x3f80, 0x3f80, 0x3f80, 0, 0, 0, 0, 0
.short 0x3f80, 0x3f80, 0x3f80, 0x3f80, 0, 0, 0, 0
.short 0x3f80, 0x3f80, 0x3f80, 0x3f80, 0x3f80, 0, 0, 0
.short 0x3f80, 0x3f80, 0x3f80, 0x3f80, 0x3f80, 0x3f80, 0, 0
.short 0x3f80, 0x3f80, 0x3f80, 0x3f80, 0x3f80, 0x3f80, 0x3f80, 0
.short 0x3f80, 0x3f80, 0x3f80, 0x3f80, 0x3f80, 0x3f80, 0x3f80, 0x3f80
.short 0x3f80, 0x3f80, 0x3f80, 0x3f80, 0x3f80, 0x3f80, 0x3f80, 0x3f80
.short 0, 0x3f80, 0x3f80, 0x3f80, 0x3f80, 0x3f80, 0x3f80, 0x3f80
.short 0, 0, 0x3f80, 0x3f80, 0x3f80, 0x3f80, 0x3f80, 0x3f80
.short 0, 0, 0, 0x3f80, 0x3f80, 0x3f80, 0x3f80, 0x3f80
.short 0, 0, 0, 0, 0, 0, 0, 0
.short 0, 0, 0, 0, 0, 0, 0, 0
.short 0, 0, 0, 0, 0, 0, 0, 0
.short 0, 0, 0, 0, 0, 0, 0, 0
.short 0, 0, 0, 0, 0, 0, 0, 0
.short 0, 0, 0, 0, 0, 0, 0, 0
.short 0, 0, 0, 0, 0, 0, 0, 0
.short 0, 0, 0, 0, 0, 0, 0, 0
.short 0, 0, 0, 0, 0, 0, 0, 0
.short 0, 0, 0, 0, 0, 0, 0, 0
.short 0, 0, 0, 0, 0, 0, 0, 0
.short 0, 0, 0, 0, 0, 0, 0, 0
.short 0x3f80, 0, 0, 0, 0, 0, 0, 0
.short 0x3f80, 0x3f80, 0, 0, 0, 0, 0, 0
.short 0x3f80, 0x3f80, 0x3f80, 0, 0, 0, 0, 0
.short 0x3f80, 0x3f80, 0x3f80, 0x3f80, 0, 0, 0, 0
.short 0, 0, 0, 0, 0, 0x3f80, 0x3f80, 0x3f80
.short 0, 0, 0, 0, 0, 0, 0x3f80, 0x3f80
.short 0, 0, 0, 0, 0, 0, 0, 0x3f80
.short 0, 0, 0, 0, 0, 0, 0, 0
.short 0, 0, 0, 0, 0, 0, 0, 0
.short 0, 0, 0, 0, 0, 0, 0, 0
.short 0, 0, 0, 0, 0, 0, 0, 0
.short 0, 0, 0, 0, 0, 0, 0, 0
.short 0, 0, 0, 0, 0, 0, 0, 0
.short 0, 0, 0, 0, 0, 0, 0, 0
.short 0, 0, 0, 0, 0, 0, 0, 0
.short 0, 0, 0, 0, 0, 0, 0, 0
.short 0, 0, 0, 0, 0, 0, 0, 0
.short 0, 0, 0, 0, 0, 0, 0, 0
.short 0, 0, 0, 0, 0, 0, 0, 0
.short 0, 0, 0, 0, 0, 0, 0, 0
.short 0x3f80, 0x3f80, 0x3f80, 0x3f80, 0, 0, 0, 0
.short 0x3f80, 0x3f80, 0x3f80, 0x3f80, 0x3f80, 0, 0, 0
.short 0x3f80, 0x3f80, 0x3f80, 0x3f80, 0x3f80, 0x3f80, 0, 0
.short 0x3f80, 0x3f80, 0x3f80, 0x3f80, 0x3f80, 0x3f80, 0x3f80, 0
.short 0, 0x3f80, 0x3f80, 0x3f80, 0x3f80, 0x3f80, 0x3f80, 0x3f80
.short 0, 0, 0x3f80, 0x3f80, 0x3f80, 0x3f80, 0x3f80, 0x3f80
.short 0, 0, 0, 0x3f80, 0x3f80, 0x3f80, 0x3f80, 0x3f80
.short 0, 0, 0, 0, 0x3f80, 0x3f80, 0x3f80, 0x3f80
.short 0, 0, 0, 0, 0, 0x3f80, 0x3f80, 0x3f80
.short 0, 0, 0, 0, 0, 0, 0x3f80, 0x3f80
.short 0, 0, 0, 0, 0, 0, 0, 0x3f80
.short 0, 0, 0, 0, 0, 0, 0, 0
.short 0, 0, 0, 0, 0, 0, 0, 0
.short 0, 0, 0, 0, 0, 0, 0, 0
.short 0, 0, 0, 0, 0, 0, 0, 0
.short 0, 0, 0, 0, 0, 0, 0, 0
.short 0, 0, 0, 0, 0, 0, 0, 0
.short 0, 0, 0, 0, 0, 0, 0, 0
.short 0, 0, 0, 0, 0, 0, 0, 0
.short 0, 0, 0, 0, 0, 0, 0, 0
.short 0, 0, 0, 0, 0, 0, 0, 0
.short 0x3f80, 0, 0, 0, 0, 0, 0, 0
.short 0x3f80, 0x3f80, 0, 0, 0, 0, 0, 0
.short 0x3f80, 0x3f80, 0x3f80, 0, 0, 0, 0, 0
.short 0x3f80, 0x3f80, 0x3f80, 0x3f80, 0, 0, 0, 0
.short 0x3f80, 0x3f80, 0x3f80, 0x3f80, 0x3f80, 0, 0, 0
.short 0x3f80, 0x3f80, 0x3f80, 0x3f80, 0x3f80, 0x3f80, 0, 0
.short 0x3f80, 0x3f80, 0x3f80, 0x3f80, 0x3f80, 0x3f80, 0x3f80, 0
.short 0, 0x3f80, 0x3f80, 0x3f80, 0x3f80, 0x3f80, 0x3f80, 0x3f80
.short 0, 0, 0x3f80, 0x3f80, 0x3f80, 0x3f80, 0x3f80, 0x3f80
.short 0, 0, 0, 0x3f80, 0x3f80, 0x3f80, 0x3f80, 0x3f80
.short 0, 0, 0, 0, 0x3f80, 0x3f80, 0x3f80, 0x3f80
.short 0, 0, 0, 0, 0, 0, 0, 0
.short 0, 0, 0, 0, 0, 0, 0, 0
.short 0, 0, 0, 0, 0, 0, 0, 0
.short 0, 0, 0, 0, 0, 0, 0, 0
.short 0, 0, 0, 0, 0, 0, 0, 0
.short 0, 0, 0, 0, 0, 0, 0, 0
.short 0, 0, 0, 0, 0, 0, 0, 0
.short 0, 0, 0, 0, 0, 0, 0, 0
.short 0, 0, 0, 0, 0, 0, 0, 0
.short 0, 0, 0, 0, 0, 0, 0, 0
.short 0, 0, 0, 0, 0, 0, 0, 0
.short 0, 0, 0, 0, 0, 0, 0, 0
.short 0, 0, 0, 0, 0, 0, 0, 0
.short 0x3f80, 0, 0, 0, 0, 0, 0, 0
.short 0x3f80, 0x3f80, 0, 0, 0, 0, 0, 0
.short 0x3f80, 0x3f80, 0x3f80, 0, 0, 0, 0, 0
L_tend:
.section .rodata,"a"
.p2align 6
.amdhsa_kernel sequential_preLN__ssm_conv_s4__moe_arch_mod__prompt_kernel
  .amdhsa_next_free_vgpr 256
  .amdhsa_next_free_sgpr 102
  .amdhsa_accum_offset 256
  .amdhsa_group_segment_fixed_size 0
  .amdhsa_kernarg_size 136
  .amdhsa_user_sgpr_count 2
  .amdhsa_user_sgpr_kernarg_segment_ptr 1
  .amdhsa_system_sgpr_workgroup_id_x 1
.end_amdhsa_kernel
```
